```python
import torch

def _softmax(x, axis=-1):
    return torch.softmax(x, dim=axis)
def _gelu(x):
    return torch.nn.functional.gelu(x, approximate="tanh")
def _silu(x):
    return torch.nn.functional.silu(x)
def _sigmoid(x):
    return torch.sigmoid(x)
def _layernorm(x, axis=-1, eps=1e-5):
    m = x.mean(dim=axis, keepdim=True)
    v = x.var(dim=axis, keepdim=True, unbiased=False)
    return (x - m) / torch.sqrt(v + eps)
def _scatter_add(tgt, idx, src, axis=0):
    return tgt.clone().index_add_(axis, idx, src)
def _segment_sum(src, seg, n):
    out = torch.zeros((n,) + src.shape[1:], dtype=src.dtype)
    return out.index_add_(0, seg, src)
def _pad(x, pw):
    flat = tuple(v for pair in reversed(pw) for v in pair)
    return torch.nn.functional.pad(x, flat)

kernel_name = 'sequential_preLN__sliding_block_cached__dense_activation_gelu__decode'

def setup_inputs():

    _w = (lambda a: (lambda t: t.to(torch.bfloat16) if t.is_floating_point() else t)(torch.as_tensor(a)))
    def _A_setup():
        B, Sq, D = 1, 1, 512
        Hq, Hkv, Sk, Dh = 32, 32, 16384, 128
        assert Hq % Hkv == 0, (Hq, Hkv)
        return {
            "x": _w((lambda *s: torch.randn(*s, dtype=torch.bfloat16) * 0.1)(B, Sq, D)),
            "k_cache": _w((lambda *s: torch.randn(*s, dtype=torch.bfloat16) * 1.6)(B, Hkv, Sk, Dh)),
            "v_cache": _w((lambda *s: torch.randn(*s, dtype=torch.bfloat16) * 1.6)(B, Hkv, Sk, Dh)),
            "wq": _w((lambda *s: torch.randn(*s, dtype=torch.bfloat16) * 1.6)(D, Hq * Dh) * (D ** -0.5)),
            "wo": _w((lambda *s: torch.randn(*s, dtype=torch.bfloat16) * 1.6)(Hq * Dh, D) * ((Hq * Dh) ** -0.5)),
        }
    _A_in = _A_setup()

    def _B_setup():
        B, S, D, F = 1, 1, 512, 1376
        return {
            "x": _w((lambda *s: torch.randn(*s, dtype=torch.bfloat16) * 0.1)(B, S, D)),
            "w1": _w((lambda *s: torch.randn(*s, dtype=torch.bfloat16) * 3.2)(D, F) * (D ** -0.5)),
            "b1": _w((lambda *s: torch.randn(*s, dtype=torch.bfloat16) * 3.2)(F) * 0.01),
            "w2": _w((lambda *s: torch.randn(*s, dtype=torch.bfloat16) * 3.2)(F, D) * (F ** -0.5)),
            "b2": _w((lambda *s: torch.randn(*s, dtype=torch.bfloat16) * 3.2)(D) * 0.01),
        }
    _B_in = _B_setup()

    return {
        "A_x": _A_in["x"],
        "A_k_cache": _A_in["k_cache"],
        "A_v_cache": _A_in["v_cache"],
        "A_wq": _A_in["wq"],
        "A_wo": _A_in["wo"],
        "B_x": _B_in["x"],
        "B_w1": _B_in["w1"],
        "B_b1": _B_in["b1"],
        "B_w2": _B_in["w2"],
        "B_b2": _B_in["b2"],
    }

def reference(A_x, A_k_cache, A_v_cache, A_wq, A_wo, B_x, B_w1, B_b1, B_w2, B_b2):
    def _A_ref(x, k_cache, v_cache, wq, wo):
        B, Sq, D = x.shape
        Hq, Dh = 32, 128
        Hkv, Sk = k_cache.shape[1], k_cache.shape[2]
        W = min(4096, max(256, Sk // 4))
        rep = Hq // Hkv
        q = (lambda x, *d: x.permute(*d))((x @ wq).reshape(B, Sq, Hq, Dh), 0, 2, 1, 3)
        k = (lambda x, n, axis: torch.repeat_interleave(x, n, dim=axis))(k_cache[:, :, Sk - W:, :], rep, axis=1)
        v = (lambda x, n, axis: torch.repeat_interleave(x, n, dim=axis))(v_cache[:, :, Sk - W:, :], rep, axis=1)
        scores = torch.einsum("bhqd,bhkd->bhqk", q, k) * (Dh ** -0.5)
        p = _softmax(scores, axis=-1)
        o = torch.einsum("bhqk,bhkd->bhqd", p, v)
        return (lambda x, *d: x.permute(*d))(o, 0, 2, 1, 3).reshape(B, Sq, Hq * Dh) @ wo

    def _B_ref(x, w1, b1, w2, b2):
        h = torch.einsum("bsd,df->bsf", x, w1) + b1
        h = _gelu(h)
        return torch.einsum("bsf,fd->bsd", h, w2) + b2

    x = A_x
    h = x + _A_ref(_layernorm(x, axis=-1), A_k_cache, A_v_cache, A_wq, A_wo)
    h2 = h + _B_ref(_layernorm(h, axis=-1), B_w1, B_b1, B_w2, B_b2)
    return h2
```

```asm
; @launch grid=(256,1,1) block=(1024,1,1) lds=88064
.amdgcn_target "amdgcn-amd-amdhsa--gfx950"
.text
.globl sequential_preLN__sliding_block_cached__dense_activation_gelu__decode_kernel
.p2align 8
.type sequential_preLN__sliding_block_cached__dense_activation_gelu__decode_kernel,@function
sequential_preLN__sliding_block_cached__dense_activation_gelu__decode_kernel:
  s_cmp_ge_u32 s2, 256
  s_cbranch_scc1 L_end
  s_load_dwordx16 s[4:19], s[0:1], 0
  v_lshrrev_b32 v13, 6, v0
  s_load_dwordx8 s[20:27], s[0:1], 64
  v_and_b32 v1, 63, v0
  v_readfirstlane_b32 s3, v13
  s_load_dwordx2 s[28:29], s[0:1], 96
  v_lshlrev_b32 v2, 4, v1
  s_sub_u32 s38, s3, 4
  s_cmp_lt_u32 s38, 8
  s_cbranch_scc1 L_bar
  s_setprio 2
  s_and_b32 s30, s2, 7
  s_lshr_b32 s31, s2, 3
  s_and_b32 s32, s31, 3
  s_lshr_b32 s33, s31, 2
  s_lshl2_add_u32 s34, s30, s32
  s_cmp_ge_u32 s3, 12
  s_cbranch_scc1 L_q0
  s_lshl_b32 s35, s34, 5
  s_add_u32 s35, s35, s33
  s_add_u32 s35, s35, 24
  s_lshl_b32 s35, s35, 17
  s_mul_i32 s36, s2, 5
  s_lshr_b32 s37, s3, 2
  s_mul_i32 s37, s37, 1
  s_add_u32 s36, s36, s37
  s_and_b32 s37, s3, 3
  s_mul_i32 s37, s37, 4
  s_add_u32 s36, s36, s37
  s_lshl_b32 s36, s36, 10
  s_movk_i32 s88, 16384
  s_mov_b32 s50, 0x20000
  s_sub_u32 s89, s50, 1
  s_and_b32 s40, s36, s89
  s_mov_b32 s51, 0x20000
  s_waitcnt lgkmcnt(0)
  s_add_u32 s48, s6, s35
  s_addc_u32 s49, s7, 0
  s_and_b32 s49, s49, 0xffff
  buffer_load_dwordx4 v[64:67], v2, s[48:51], s40 offen nt
  s_add_u32 s41, s40, s88
  s_and_b32 s41, s41, s89
  buffer_load_dwordx4 v[68:71], v2, s[48:51], s41 offen nt
  s_barrier
  s_branch L_kv2
L_q0:
  s_setprio 3
  s_sub_u32 s38, s3, 12
  v_lshrrev_b32 v17, 4, v1
  v_and_b32 v18, 15, v1
  s_mov_b32 s58, 0x400000
  s_mov_b32 s59, 0x20000
  s_lshl2_add_u32 s98, s33, s38
  s_cmp_ge_u32 s31, 16
  s_cbranch_scc1 L_q0w
  v_lshlrev_b32 v20, 13, v17
  v_lshl_add_u32 v20, v18, 4, v20
  s_lshl_b32 s97, s98, 18
  s_lshl_b32 s99, s34, 8
  s_add_u32 s97, s97, s99
  s_mov_b32 s99, 0x8000
  s_waitcnt lgkmcnt(0)
  s_mov_b32 s56, s10
  s_and_b32 s57, s11, 0xffff
  global_load_dwordx4 v[8:11], v2, s[4:5]
  s_branch L_q0l
L_q0w:
  v_lshrrev_b32 v21, 3, v1
  v_and_b32 v22, 7, v1
  v_lshlrev_b32 v20, 10, v21
  v_lshl_add_u32 v20, v22, 4, v20
  s_bfe_u32 s97, s31, 0x10003
  s_lshl1_add_u32 s97, s30, s97
  s_lshl2_add_u32 s97, s97, s38
  s_lshl_b32 s97, s97, 16
  s_and_b32 s99, s31, 7
  s_lshl_b32 s99, s99, 7
  s_add_u32 s97, s97, s99
  s_movk_i32 s99, 0x2000
  s_waitcnt lgkmcnt(0)
  s_mov_b32 s56, s12
  s_and_b32 s57, s13, 0xffff
L_q0l:
  buffer_load_dwordx4 v[64:67], v20, s[56:59], s97 offen nt
  s_add_u32 s97, s97, s99
  buffer_load_dwordx4 v[68:71], v20, s[56:59], s97 offen nt
  s_add_u32 s97, s97, s99
  buffer_load_dwordx4 v[72:75], v20, s[56:59], s97 offen nt
  s_add_u32 s97, s97, s99
  buffer_load_dwordx4 v[76:79], v20, s[56:59], s97 offen nt
  s_add_u32 s97, s97, s99
  buffer_load_dwordx4 v[80:83], v20, s[56:59], s97 offen nt
  s_add_u32 s97, s97, s99
  buffer_load_dwordx4 v[84:87], v20, s[56:59], s97 offen nt
  s_add_u32 s97, s97, s99
  buffer_load_dwordx4 v[88:91], v20, s[56:59], s97 offen nt
  s_add_u32 s97, s97, s99
  buffer_load_dwordx4 v[92:95], v20, s[56:59], s97 offen nt
  v_mov_b32 v20, 0
  v_mov_b32 v21, 0
  v_lshlrev_b32 v14, 3, v1
  s_mov_b64 exec, 0xff
  ds_write_b64 v14, v[20:21] offset:10240
  s_mov_b64 exec, -1
  s_lshl_b32 s98, s98, 5
  v_and_b32 v19, 7, v18
  v_lshl_add_u32 v19, v19, 2, v17
  v_add_lshl_u32 v19, v19, s98, 1
  s_waitcnt lgkmcnt(0)
L_bar:
  s_barrier
  s_and_b32 s30, s2, 7
  s_lshr_b32 s31, s2, 3
  s_and_b32 s32, s31, 3
  s_lshr_b32 s33, s31, 2
  s_lshl2_add_u32 s34, s30, s32
  s_lshl_b32 s35, s34, 5
  s_add_u32 s35, s35, s33
  s_add_u32 s35, s35, 24
  s_lshl_b32 s35, s35, 17
  s_mul_i32 s36, s2, 5
  s_lshr_b32 s37, s3, 2
  s_mul_i32 s37, s37, 1
  s_add_u32 s36, s36, s37
  s_and_b32 s37, s3, 3
  s_mul_i32 s37, s37, 4
  s_add_u32 s36, s36, s37
  s_lshl_b32 s36, s36, 10
  s_movk_i32 s88, 16384
  s_mov_b32 s50, 0x20000
  s_sub_u32 s89, s50, 1
  s_and_b32 s40, s36, s89
  s_mov_b32 s51, 0x20000
  s_waitcnt lgkmcnt(0)
  s_add_u32 s48, s6, s35
  s_addc_u32 s49, s7, 0
  s_and_b32 s49, s49, 0xffff
  s_branch L_hi
L_kv:
  s_setprio 2
  s_nop 0
  buffer_load_dwordx4 v[64:67], v2, s[48:51], s40 offen nt
  s_add_u32 s41, s40, s88
  s_and_b32 s41, s41, s89
  buffer_load_dwordx4 v[68:71], v2, s[48:51], s41 offen nt
L_kv2:
  s_add_u32 s42, s41, s88
  s_and_b32 s42, s42, s89
  buffer_load_dwordx4 v[72:75], v2, s[48:51], s42 offen nt
  s_add_u32 s43, s42, s88
  s_and_b32 s43, s43, s89
  buffer_load_dwordx4 v[76:79], v2, s[48:51], s43 offen nt
  s_add_u32 s44, s43, s88
  s_and_b32 s44, s44, s89
  buffer_load_dwordx4 v[80:83], v2, s[48:51], s44 offen nt
  s_add_u32 s45, s44, s88
  s_and_b32 s45, s45, s89
  buffer_load_dwordx4 v[84:87], v2, s[48:51], s45 offen nt
  s_add_u32 s46, s45, s88
  s_and_b32 s46, s46, s89
  buffer_load_dwordx4 v[88:91], v2, s[48:51], s46 offen nt
  s_add_u32 s47, s46, s88
  s_and_b32 s47, s47, s89
  buffer_load_dwordx4 v[92:95], v2, s[48:51], s47 offen nt
  s_add_u32 s52, s8, s35
  s_addc_u32 s53, s9, 0
  s_and_b32 s53, s53, 0xffff
  s_mov_b32 s54, 0x20000
  s_mov_b32 s55, 0x20000
  s_setprio 0
  buffer_load_dwordx4 v[96:99], v2, s[52:55], s40 offen nt
  buffer_load_dwordx4 v[100:103], v2, s[52:55], s41 offen nt
  buffer_load_dwordx4 v[104:107], v2, s[52:55], s42 offen nt
  buffer_load_dwordx4 v[108:111], v2, s[52:55], s43 offen nt
  buffer_load_dwordx4 v[112:115], v2, s[52:55], s44 offen nt
  buffer_load_dwordx4 v[116:119], v2, s[52:55], s45 offen nt
  buffer_load_dwordx4 v[120:123], v2, s[52:55], s46 offen nt
  buffer_load_dwordx4 v[124:127], v2, s[52:55], s47 offen nt
  s_cmp_ge_u32 s3, 4
  s_cbranch_scc1 L_kvdone
  s_load_dword s94, s[28:29], 458752
  v_mov_b32 v15, 10240
  v_mov_b32 v14, 1
  v_lshrrev_b32 v17, 4, v1
  v_and_b32 v18, 15, v1
  s_lshl3_add_u32 s39, s34, s33
  s_lshl_b32 s39, s39, 10
  v_and_b32 v20, 1, v18
  v_lshlrev_b32 v20, 4, v20
  v_mov_b32 v21, 0xffff
  v_lshlrev_b32 v21, v20, v21
  v_lshrrev_b32 v20, 1, v18
  v_cmp_eq_u32 vcc, 0, v20
  s_nop 1
  v_cndmask_b32 v4, 0, v21, vcc
  v_cmp_eq_u32 vcc, 1, v20
  s_nop 1
  v_cndmask_b32 v5, 0, v21, vcc
  v_cmp_eq_u32 vcc, 2, v20
  s_nop 1
  v_cndmask_b32 v6, 0, v21, vcc
  v_cmp_eq_u32 vcc, 3, v20
  s_nop 1
  v_cndmask_b32 v7, 0, v21, vcc
  v_mov_b32 v12, 0xff
  v_mov_b32 v13, 0
  v_lshlrev_b32 v3, 3, v18
  v_lshl_add_u32 v3, v17, 8, v3
  s_waitcnt lgkmcnt(0)
  s_add_u32 s94, s94, 1
  s_and_b32 s94, s94, 0xff
L_kvdone:
  s_mov_b64 exec, 0x1
  ds_add_u32 v15, v14 offset:8
  s_mov_b64 exec, -1
  s_mov_b32 s60, s28
  s_and_b32 s61, s29, 0xffff
  s_mov_b32 s62, 2097152
  s_mov_b32 s63, 0x20000
  s_bfe_u32 s92, s31, 0x10003
  s_lshl1_add_u32 s92, s30, s92
  s_and_b32 s93, s31, 7
  s_mul_i32 s95, s94, 0x01010101
  s_lshl_b32 s99, s3, 9
  v_add_u32 v3, s99, v3
  v_lshlrev_b32 v19, 4, v18
  s_mov_b32 s100, 262144
L_sp1:
  ds_read_b32 v16, v15 offset:4
  s_sub_u32 s100, s100, 1
  s_cbranch_scc1 L_spd1
  s_waitcnt lgkmcnt(0)
  v_readfirstlane_b32 s99, v16
  s_nop 0
  s_cmp_ge_u32 s99, 4
  s_cbranch_scc1 L_spd1
  s_sleep 2
  s_branch L_sp1
L_spd1:
  ds_read_b128 v[28:31], v19 offset:10304
  v_mov_b32 v16, 0
  v_mov_b32 v17, 0
  v_mov_b32 v18, 0
  v_mov_b32 v19, 0
  v_mov_b32 v20, 0
  v_mov_b32 v21, 0
  v_mov_b32 v22, 0
  v_mov_b32 v23, 0
  s_waitcnt vmcnt(8) lgkmcnt(0)
  v_dot2c_f32_bf16 v16, v64, v28
  v_dot2c_f32_bf16 v17, v68, v28
  v_dot2c_f32_bf16 v18, v72, v28
  v_dot2c_f32_bf16 v19, v76, v28
  v_dot2c_f32_bf16 v20, v80, v28
  v_dot2c_f32_bf16 v21, v84, v28
  v_dot2c_f32_bf16 v22, v88, v28
  v_dot2c_f32_bf16 v23, v92, v28
  v_dot2c_f32_bf16 v16, v65, v29
  v_dot2c_f32_bf16 v17, v69, v29
  v_dot2c_f32_bf16 v18, v73, v29
  v_dot2c_f32_bf16 v19, v77, v29
  v_dot2c_f32_bf16 v20, v81, v29
  v_dot2c_f32_bf16 v21, v85, v29
  v_dot2c_f32_bf16 v22, v89, v29
  v_dot2c_f32_bf16 v23, v93, v29
  v_dot2c_f32_bf16 v16, v66, v30
  v_dot2c_f32_bf16 v17, v70, v30
  v_dot2c_f32_bf16 v18, v74, v30
  v_dot2c_f32_bf16 v19, v78, v30
  v_dot2c_f32_bf16 v20, v82, v30
  v_dot2c_f32_bf16 v21, v86, v30
  v_dot2c_f32_bf16 v22, v90, v30
  v_dot2c_f32_bf16 v23, v94, v30
  v_dot2c_f32_bf16 v16, v67, v31
  v_dot2c_f32_bf16 v17, v71, v31
  v_dot2c_f32_bf16 v18, v75, v31
  v_dot2c_f32_bf16 v19, v79, v31
  v_dot2c_f32_bf16 v20, v83, v31
  v_dot2c_f32_bf16 v21, v87, v31
  v_dot2c_f32_bf16 v22, v91, v31
  v_dot2c_f32_bf16 v23, v95, v31
  v_add_f32_dpp v24, v16, v16 row_ror:8 row_mask:0xf bank_mask:0x3
  v_add_f32_dpp v25, v17, v17 row_ror:8 row_mask:0xf bank_mask:0x3
  v_add_f32_dpp v26, v18, v18 row_ror:8 row_mask:0xf bank_mask:0x3
  v_add_f32_dpp v27, v19, v19 row_ror:8 row_mask:0xf bank_mask:0x3
  v_add_f32_dpp v24, v20, v20 row_ror:8 row_mask:0xf bank_mask:0xc
  v_add_f32_dpp v25, v21, v21 row_ror:8 row_mask:0xf bank_mask:0xc
  v_add_f32_dpp v26, v22, v22 row_ror:8 row_mask:0xf bank_mask:0xc
  v_add_f32_dpp v27, v23, v23 row_ror:8 row_mask:0xf bank_mask:0xc
  v_add_f32_dpp v8, v24, v24 row_half_mirror row_mask:0xf bank_mask:0x5
  v_add_f32_dpp v9, v25, v25 row_half_mirror row_mask:0xf bank_mask:0x5
  v_add_f32_dpp v8, v26, v26 row_half_mirror row_mask:0xf bank_mask:0xa
  v_add_f32_dpp v9, v27, v27 row_half_mirror row_mask:0xf bank_mask:0xa
  s_nop 0
  v_add_f32_dpp v8, v8, v8 quad_perm:[1,0,3,2] row_mask:0xf bank_mask:0xf
  v_add_f32_dpp v9, v9, v9 quad_perm:[1,0,3,2] row_mask:0xf bank_mask:0xf
  s_nop 0
  v_add_f32_dpp v8, v8, v8 quad_perm:[2,3,0,1] row_mask:0xf bank_mask:0xf
  v_add_f32_dpp v9, v9, v9 quad_perm:[2,3,0,1] row_mask:0xf bank_mask:0xf
  v_cvt_pk_bf16_f32 v8, 0, v8
  v_cvt_pk_bf16_f32 v9, 0, v9
  v_mul_f32 v8, 0x3db504f3, v8
  v_mul_f32 v9, 0x3db504f3, v9
  v_cvt_pk_bf16_f32 v8, 0, v8
  v_cvt_pk_bf16_f32 v9, 0, v9
  v_max_f32 v10, v8, v9
  s_nop 1
  v_max_f32_dpp v10, v10, v10 row_half_mirror row_mask:0xf bank_mask:0xf
  s_nop 1
  v_max_f32_dpp v10, v10, v10 row_mirror row_mask:0xf bank_mask:0xf
  s_nop 1
  v_max_f32_dpp v10, v10, v10 row_bcast:15 row_mask:0xa bank_mask:0xf
  s_nop 1
  v_max_f32_dpp v10, v10, v10 row_bcast:31 row_mask:0xc bank_mask:0xf
  s_nop 0
  v_readlane_b32 s99, v10, 63
  s_nop 1
  v_subrev_f32 v8, s99, v8
  v_subrev_f32 v9, s99, v9
  v_mul_f32 v8, 0x3fb8aa3b, v8
  v_mul_f32 v9, 0x3fb8aa3b, v9
  v_exp_f32 v8, v8
  v_exp_f32 v9, v9
  v_cvt_pk_bf16_f32 v16, v8, v8
  v_cvt_pk_bf16_f32 v17, v9, v9
  v_add_f32 v11, v8, v9
  v_and_b32_dpp v64, v16, v4 row_newbcast:0 row_mask:0xf bank_mask:0xf
  v_and_b32_dpp v65, v16, v5 row_newbcast:0 row_mask:0xf bank_mask:0xf
  v_and_b32_dpp v66, v16, v6 row_newbcast:0 row_mask:0xf bank_mask:0xf
  v_and_b32_dpp v67, v16, v7 row_newbcast:0 row_mask:0xf bank_mask:0xf
  v_add_f32_dpp v11, v11, v11 row_half_mirror row_mask:0xf bank_mask:0xf
  v_and_b32_dpp v68, v17, v4 row_newbcast:0 row_mask:0xf bank_mask:0xf
  v_and_b32_dpp v69, v17, v5 row_newbcast:0 row_mask:0xf bank_mask:0xf
  v_and_b32_dpp v70, v17, v6 row_newbcast:0 row_mask:0xf bank_mask:0xf
  v_and_b32_dpp v71, v17, v7 row_newbcast:0 row_mask:0xf bank_mask:0xf
  v_add_f32_dpp v11, v11, v11 row_mirror row_mask:0xf bank_mask:0xf
  v_and_b32_dpp v72, v16, v4 row_newbcast:4 row_mask:0xf bank_mask:0xf
  v_and_b32_dpp v73, v16, v5 row_newbcast:4 row_mask:0xf bank_mask:0xf
  v_and_b32_dpp v74, v16, v6 row_newbcast:4 row_mask:0xf bank_mask:0xf
  v_and_b32_dpp v75, v16, v7 row_newbcast:4 row_mask:0xf bank_mask:0xf
  v_add_f32_dpp v11, v11, v11 row_bcast:15 row_mask:0xa bank_mask:0xf
  v_and_b32_dpp v76, v17, v4 row_newbcast:4 row_mask:0xf bank_mask:0xf
  v_and_b32_dpp v77, v17, v5 row_newbcast:4 row_mask:0xf bank_mask:0xf
  v_and_b32_dpp v78, v17, v6 row_newbcast:4 row_mask:0xf bank_mask:0xf
  v_and_b32_dpp v79, v17, v7 row_newbcast:4 row_mask:0xf bank_mask:0xf
  v_add_f32_dpp v11, v11, v11 row_bcast:31 row_mask:0xc bank_mask:0xf
  s_lshl_b32 s99, s3, 3
  v_mov_b32 v9, s99
  s_mov_b32 exec_lo, 0x0
  s_mov_b32 exec_hi, 0x80000000
  ds_write_b64 v9, v[10:11] offset:10560
  s_mov_b64 exec, 0x1
  ds_add_u32 v15, v14 offset:12
  s_mov_b64 exec, -1
  v_and_b32_dpp v80, v16, v4 row_newbcast:8 row_mask:0xf bank_mask:0xf
  v_and_b32_dpp v81, v16, v5 row_newbcast:8 row_mask:0xf bank_mask:0xf
  v_and_b32_dpp v82, v16, v6 row_newbcast:8 row_mask:0xf bank_mask:0xf
  v_and_b32_dpp v83, v16, v7 row_newbcast:8 row_mask:0xf bank_mask:0xf
  v_and_b32_dpp v84, v17, v4 row_newbcast:8 row_mask:0xf bank_mask:0xf
  v_and_b32_dpp v85, v17, v5 row_newbcast:8 row_mask:0xf bank_mask:0xf
  v_and_b32_dpp v86, v17, v6 row_newbcast:8 row_mask:0xf bank_mask:0xf
  v_and_b32_dpp v87, v17, v7 row_newbcast:8 row_mask:0xf bank_mask:0xf
  v_and_b32_dpp v88, v16, v4 row_newbcast:12 row_mask:0xf bank_mask:0xf
  v_and_b32_dpp v89, v16, v5 row_newbcast:12 row_mask:0xf bank_mask:0xf
  v_and_b32_dpp v90, v16, v6 row_newbcast:12 row_mask:0xf bank_mask:0xf
  v_and_b32_dpp v91, v16, v7 row_newbcast:12 row_mask:0xf bank_mask:0xf
  v_and_b32_dpp v92, v17, v4 row_newbcast:12 row_mask:0xf bank_mask:0xf
  v_and_b32_dpp v93, v17, v5 row_newbcast:12 row_mask:0xf bank_mask:0xf
  v_and_b32_dpp v94, v17, v6 row_newbcast:12 row_mask:0xf bank_mask:0xf
  v_and_b32_dpp v95, v17, v7 row_newbcast:12 row_mask:0xf bank_mask:0xf
  s_cmp_lt_u32 s3, 12
  s_cbranch_scc1 L_pv
  v_lshrrev_b32 v17, 4, v1
  v_and_b32 v18, 15, v1
  v_lshl_add_u32 v8, v17, 2, v18
  v_and_b32 v8, 15, v8
  v_lshlrev_b32 v8, 3, v8
  v_lshlrev_b32 v11, 11, v17
  v_lshl_add_u32 v11, v18, 3, v11
  s_lshl_b32 s36, s38, 7
  v_add_u32 v11, s36, v11
  v_lshl_add_u32 v9, v1, 2, s36
  s_add_u32 s37, s39, 786432
  s_mov_b32 s100, 262144
L_sp2:
  ds_read_b32 v16, v15 offset:12
  s_sub_u32 s100, s100, 1
  s_cbranch_scc1 L_spd2
  s_waitcnt lgkmcnt(0)
  v_readfirstlane_b32 s99, v16
  s_nop 0
  s_cmp_ge_u32 s99, 16
  s_cbranch_scc1 L_spd2
  s_sleep 1
  s_branch L_sp2
L_spd2:
  ds_read_b64 v[28:29], v8 offset:10560
  s_waitcnt lgkmcnt(0)
  v_max_f32_dpp v20, v28, v28 quad_perm:[1,0,3,2] row_mask:0xf bank_mask:0xf
  s_nop 1
  v_max_f32_dpp v20, v20, v20 quad_perm:[2,3,0,1] row_mask:0xf bank_mask:0xf
  s_nop 1
  v_max_f32_dpp v20, v20, v20 row_half_mirror row_mask:0xf bank_mask:0xf
  s_nop 1
  v_max_f32_dpp v20, v20, v20 row_mirror row_mask:0xf bank_mask:0xf
  v_sub_f32 v28, v28, v20
  v_mul_f32 v28, 0x3fb8aa3b, v28
  v_exp_f32 v28, v28
  s_nop 0
  v_mul_f32 v21, v28, v29
  s_nop 1
  v_add_f32_dpp v21, v21, v21 quad_perm:[1,0,3,2] row_mask:0xf bank_mask:0xf
  s_nop 1
  v_add_f32_dpp v21, v21, v21 quad_perm:[2,3,0,1] row_mask:0xf bank_mask:0xf
  s_nop 1
  v_add_f32_dpp v21, v21, v21 row_half_mirror row_mask:0xf bank_mask:0xf
  s_nop 1
  v_add_f32_dpp v21, v21, v21 row_mirror row_mask:0xf bank_mask:0xf
  v_bfi_b32 v20, v12, s94, v20
  v_bfi_b32 v21, v12, s94, v21
  v_mov_b32 v22, s95
  v_mov_b32 v23, s95
  v_mov_b32_dpp v31, v28 row_newbcast:3 row_mask:0xf bank_mask:0xf
  v_mov_b32_dpp v30, v28 row_newbcast:2 row_mask:0xf bank_mask:0xf
  v_mov_b32_dpp v29, v28 row_newbcast:1 row_mask:0xf bank_mask:0xf
  v_mov_b32_dpp v28, v28 row_newbcast:0 row_mask:0xf bank_mask:0xf
  s_setprio 3
L_pv:
  s_waitcnt vmcnt(7)
  v_mfma_f32_16x16x32_bf16 v[24:27], v[64:67], v[96:99], 0
  s_waitcnt vmcnt(6)
  v_mfma_f32_16x16x32_bf16 v[24:27], v[68:71], v[100:103], v[24:27]
  s_waitcnt vmcnt(5)
  v_mfma_f32_16x16x32_bf16 v[24:27], v[72:75], v[104:107], v[24:27]
  s_waitcnt vmcnt(4)
  v_mfma_f32_16x16x32_bf16 v[24:27], v[76:79], v[108:111], v[24:27]
  s_waitcnt vmcnt(3)
  v_mfma_f32_16x16x32_bf16 v[24:27], v[80:83], v[112:115], v[24:27]
  s_waitcnt vmcnt(2)
  v_mfma_f32_16x16x32_bf16 v[24:27], v[84:87], v[116:119], v[24:27]
  s_waitcnt vmcnt(1)
  v_mfma_f32_16x16x32_bf16 v[24:27], v[88:91], v[120:123], v[24:27]
  s_waitcnt vmcnt(0)
  v_mfma_f32_16x16x32_bf16 v[24:27], v[92:95], v[124:127], v[24:27]
  s_mov_b32 exec_hi, 0
  s_nop 6
  ds_write2_b64 v3, v[24:25], v[26:27] offset0:0 offset1:16
  s_mov_b64 exec, 0x1
  ds_add_u32 v15, v14 offset:16
  s_mov_b64 exec, -1
  s_cmp_lt_u32 s3, 12
  s_cbranch_scc1 L_roles
  s_cmp_gt_u32 s3, 13
  s_cbranch_scc1 L_noml
  s_mov_b64 exec, 1
  s_cmp_eq_u32 s3, 12
  s_cbranch_scc1 L_ml2
  buffer_store_dwordx4 v[20:23], off, s[60:63], s39 offset:512 sc1
  s_branch L_ml3
L_ml2:
  buffer_store_dwordx4 v[20:23], off, s[60:63], s37 offset:512
L_ml3:
  s_mov_b64 exec, -1
L_noml:
  s_mov_b32 s100, 262144
L_sp3:
  ds_read_b32 v16, v15 offset:16
  ds_read_b64 v[32:33], v11 offset:0
  ds_read_b64 v[34:35], v11 offset:512
  ds_read_b64 v[36:37], v11 offset:1024
  ds_read_b64 v[38:39], v11 offset:1536
  s_sub_u32 s100, s100, 1
  s_cbranch_scc1 L_spd3
  s_waitcnt lgkmcnt(4)
  v_readfirstlane_b32 s99, v16
  s_nop 0
  s_cmp_ge_u32 s99, 16
  s_cbranch_scc0 L_sp3
L_spd3:
  s_waitcnt lgkmcnt(3)
  v_mul_f32 v16, v32, v28
  v_mul_f32 v17, v33, v28
  s_waitcnt lgkmcnt(2)
  v_fmac_f32 v16, v34, v29
  v_fmac_f32 v17, v35, v29
  s_waitcnt lgkmcnt(1)
  v_fmac_f32 v16, v36, v30
  v_fmac_f32 v17, v37, v30
  s_waitcnt lgkmcnt(0)
  v_fmac_f32 v16, v38, v31
  v_fmac_f32 v17, v39, v31
  s_nop 1
  v_permlane16_swap_b32 v16, v17
  v_add_f32 v16, v16, v17
  v_mov_b32 v17, v16
  s_nop 1
  v_permlane32_swap_b32 v16, v17
  v_add_f32 v16, v16, v17
  s_mov_b32 exec_hi, 0
  v_bfi_b32 v16, v12, s94, v16
  buffer_store_dword v16, v9, s[60:63], s37 offen
  buffer_store_dword v16, v9, s[60:63], s39 offen sc1
  s_mov_b64 exec, 0x1
  ds_add_u32 v15, v14 offset:20
  s_mov_b64 exec, -1
  s_setprio 0
L_roles:
  s_cmp_ge_u32 s31, 16
  s_cbranch_scc1 L_role_wo
  s_cmp_lg_u32 s3, 0
  s_cbranch_scc1 L_notk
  s_mov_b32 s100, 262144
L_sp4:
  ds_read_b32 v16, v15 offset:8
  s_sub_u32 s100, s100, 1
  s_cbranch_scc1 L_spd4
  s_waitcnt lgkmcnt(0)
  v_readfirstlane_b32 s99, v16
  s_nop 0
  s_cmp_ge_u32 s99, 16
  s_cbranch_scc1 L_spd4
  s_sleep 1
  s_branch L_sp4
L_spd4:
  s_mov_b64 exec, 1
  global_atomic_add v20, v13, v14, s[26:27] sc0 sc1
  s_waitcnt vmcnt(0)
  v_and_b32 v20, 127, v20
  v_add_u32 v20, 1, v20
  ds_write_b32 v15, v20 offset:44
  s_mov_b64 exec, -1
L_notk:
  s_mov_b32 s100, 262144
L_sp5:
  ds_read_b32 v16, v15 offset:44
  s_sub_u32 s100, s100, 1
  s_cbranch_scc1 L_spd5
  s_waitcnt lgkmcnt(0)
  v_readfirstlane_b32 s99, v16
  s_nop 0
  s_cmp_ge_u32 s99, 1
  s_cbranch_scc1 L_spd5
  s_sleep 1
  s_branch L_sp5
L_spd5:
  s_sub_u32 s98, s99, 1
  s_cmp_lt_u32 s98, 43
  s_cbranch_scc1 L_role_ffn
  s_sub_u32 s98, s98, 43
  s_cmp_ge_u32 s98, 16
  s_cbranch_scc1 L_fin
  s_lshr_b32 s30, s98, 1
  s_and_b32 s31, s98, 1
  s_cmp_lt_u32 s3, 7
  s_cbranch_scc1 L_role_red
L_fin:
  s_endpgm
L_role_wo:
  s_cmp_ge_u32 s3, 8
  s_cbranch_scc1 L_fin
  v_lshrrev_b32 v17, 4, v1
  v_and_b32 v18, 15, v1
  s_and_b32 s101, s3, 3
  s_cmp_ge_u32 s3, 4
  s_cbranch_scc1 L_wo_p2
  v_lshlrev_b32 v30, 10, v17
  v_lshl_add_u32 v31, v18, 4, v30
  v_lshl_add_u32 v30, v18, 12, v30
  s_lshr_b32 s99, s101, 1
  s_lshl1_add_u32 s40, s92, s99
  s_lshl_b32 s40, s40, 13
  s_mov_b32 s46, 0x00030003
  s_mov_b32 s47, 0x00030003
  s_mov_b64 exec, s[46:47]
  v_lshlrev_b32 v25, 1, v30
  s_lshl_b32 s41, s40, 1
  s_add_u32 s41, s41, 1572864
  buffer_load_dword v24, v25, s[60:63], s41 offen offset:256 sc1
  s_getreg_b32 s99, hwreg(HW_REG_XCC_ID, 0, 4)
  s_lshl_b32 s99, s99, 8
  s_or_b32 s99, s99, s94
  s_waitcnt vmcnt(0)
  v_cmp_ne_u32 vcc, s99, v24
  s_mov_b64 exec, -1
  s_cmp_eq_u64 vcc, 0
  s_cselect_b32 s99, 786432, 0
  s_add_u32 s40, s40, s99
  s_and_b32 s41, s3, 1
  s_lshl_b32 s41, s41, 8
  s_add_u32 s41, s41, s40
  s_add_u32 s42, s41, 4096
  v_lshl_add_u32 v22, v18, 2, v17
  s_lshl_b32 s99, s101, 6
  v_add_lshl_u32 v22, v22, s99, 1
  v_mov_b32 v40, s94
  v_mov_b32 v41, s94
  v_mov_b32 v42, s95
  v_mov_b32 v52, s94
  v_mov_b32 v53, s94
  v_mov_b32 v54, s95
  buffer_load_dwordx4 v[32:35], v31, s[60:63], s41 offen sc1
  buffer_load_dwordx4 v[36:39], v31, s[60:63], s42 offen sc1
  s_mov_b64 s[90:91], exec
  s_mov_b64 exec, s[46:47]
  buffer_load_dwordx4 v[40:43], v30, s[60:63], s40 offen offset:512 sc1
  s_mov_b64 exec, s[90:91]
  s_mov_b32 s100, 262144
L_sp6:
  ds_read_b32 v16, v15 offset:16
  s_sub_u32 s100, s100, 1
  s_cbranch_scc1 L_spd6
  s_waitcnt lgkmcnt(0)
  v_readfirstlane_b32 s99, v16
  s_nop 0
  s_cmp_ge_u32 s99, 16
  s_cbranch_scc1 L_spd6
  s_sleep 1
  s_branch L_sp6
L_spd6:
  v_mov_b32 v28, 0
  v_mov_b32 v29, 0
  s_mov_b64 exec, s[46:47]
  s_mov_b32 s100, 65536
L_pm:
  buffer_load_dwordx4 v[56:59], v30, s[60:63], s40 offen offset:512 sc1
  s_waitcnt vmcnt(0)
  v_xor_b32 v17, s95, v58
  v_xor_b32 v28, s94, v56
  v_xor_b32 v29, s94, v57
  v_min_u32 v17, 1, v17
  v_or3_b32 v16, v17, v28, v29
  v_cmp_ne_u32_sdwa vcc, v16, v13 src0_sel:BYTE_0 src1_sel:DWORD
  s_cbranch_vccz L_pm_ok
  s_mov_b64 exec, vcc
  s_sub_u32 s100, s100, 1
  s_cbranch_scc0 L_pm
L_pm_ok:
  s_mov_b64 exec, -1
  buffer_load_dwordx4 v[32:35], v31, s[60:63], s41 offen sc1
  buffer_load_dwordx4 v[36:39], v31, s[60:63], s42 offen sc1
  v_max_f32_dpp v16, v28, v28 quad_perm:[1,0,3,2] row_mask:0xf bank_mask:0xf
  v_mov_b32 v17, v16
  s_nop 1
  v_permlane16_swap_b32 v16, v17
  v_max_f32 v16, v16, v17
  v_mov_b32 v17, v16
  s_nop 1
  v_permlane32_swap_b32 v16, v17
  v_max_f32 v16, v16, v17
  v_sub_f32 v16, v28, v16
  v_mul_f32 v16, 0x3fb8aa3b, v16
  v_exp_f32 v16, v16
  s_nop 0
  v_mul_f32 v29, v29, v16
  s_nop 1
  v_add_f32_dpp v29, v29, v29 quad_perm:[1,0,3,2] row_mask:0xf bank_mask:0xf
  v_mov_b32 v17, v29
  s_nop 1
  v_permlane16_swap_b32 v29, v17
  v_add_f32 v29, v29, v17
  v_mov_b32 v17, v29
  s_nop 1
  v_permlane32_swap_b32 v29, v17
  v_add_f32 v29, v29, v17
  v_rcp_f32 v29, v29
  s_nop 0
  v_mul_f32 v16, v16, v29
  s_nop 1
  v_mov_b32_dpp v28, v16 row_newbcast:0 row_mask:0xf bank_mask:0xf
  v_mov_b32_dpp v29, v16 row_newbcast:1 row_mask:0xf bank_mask:0xf
  s_mov_b32 s100, 65536
L_po:
  s_waitcnt vmcnt(0)
  v_xor_b32 v96, s94, v32
  v_xor_b32 v97, s94, v33
  v_xor_b32 v98, s94, v34
  v_xor_b32 v99, s94, v35
  v_xor_b32 v100, s94, v36
  v_xor_b32 v101, s94, v37
  v_xor_b32 v102, s94, v38
  v_xor_b32 v103, s94, v39
  v_or3_b32 v16, v96, v97, v98
  v_or3_b32 v17, v99, v100, v101
  v_or3_b32 v16, v16, v102, v103
  v_or_b32 v16, v16, v17
  v_cmp_ne_u32_sdwa vcc, v16, v13 src0_sel:BYTE_0 src1_sel:DWORD
  v_mul_f32 v104, v28, v96
  v_mul_f32 v105, v28, v97
  v_mul_f32 v106, v28, v98
  v_mul_f32 v107, v28, v99
  v_fmac_f32 v104, v29, v100
  v_fmac_f32 v105, v29, v101
  v_fmac_f32 v106, v29, v102
  v_fmac_f32 v107, v29, v103
  s_cbranch_vccz L_po_ok
  s_mov_b64 exec, vcc
  buffer_load_dwordx4 v[32:35], v31, s[60:63], s41 offen sc1
  buffer_load_dwordx4 v[36:39], v31, s[60:63], s42 offen sc1
  s_sub_u32 s100, s100, 1
  s_cbranch_scc0 L_po
L_po_ok:
  s_mov_b64 exec, -1
  v_permlane32_swap_b32 v104, v106
  v_permlane32_swap_b32 v105, v107
  v_add_f32 v104, v104, v106
  v_add_f32 v105, v105, v107
  s_nop 1
  v_permlane16_swap_b32 v104, v105
  v_add_f32 v104, v104, v105
  v_cvt_pk_bf16_f32 v104, v104, v104
  ds_write_b16 v22, v104 offset:10752
  s_mov_b64 exec, 0x1
  ds_add_u32 v15, v14 offset:32
  s_endpgm
L_wo_p2:
  v_lshlrev_b32 v23, 4, v17
  v_bfe_u32 v19, v1, 2, 2
  v_lshl_add_u32 v19, v17, 3, v19
  v_mul_u32_u24 v19, 144, v19
  v_and_b32 v20, 3, v1
  v_lshl_add_u32 v19, v20, 3, v19
  s_lshl_b32 s99, s101, 5
  v_add_u32 v19, s99, v19
  v_lshlrev_b32 v18, 2, v1
  s_lshl_b32 s37, s92, 12
  s_lshl_b32 s99, s93, 9
  s_add_u32 s37, s37, s99
  s_lshl_b32 s99, s101, 7
  s_add_u32 s37, s37, s99
  s_add_u32 s37, s37, 1048576
  s_mov_b32 s100, 262144
L_sp7:
  ds_read_b32 v16, v15 offset:24
  s_sub_u32 s100, s100, 1
  s_cbranch_scc1 L_spd7
  s_waitcnt lgkmcnt(0)
  v_readfirstlane_b32 s99, v16
  s_nop 0
  s_cmp_ge_u32 s99, 4
  s_cbranch_scc1 L_spd7
  s_sleep 1
  s_branch L_sp7
L_spd7:
  ds_read_b64_tr_b16 v[32:33], v19 offset:13824
  ds_read_b64_tr_b16 v[34:35], v19 offset:14400
  ds_read_b64_tr_b16 v[36:37], v19 offset:18432
  ds_read_b64_tr_b16 v[38:39], v19 offset:19008
  ds_read_b64_tr_b16 v[40:41], v19 offset:23040
  ds_read_b64_tr_b16 v[42:43], v19 offset:23616
  ds_read_b64_tr_b16 v[44:45], v19 offset:27648
  ds_read_b64_tr_b16 v[46:47], v19 offset:28224
  ds_read_b64_tr_b16 v[48:49], v19 offset:32256
  ds_read_b64_tr_b16 v[50:51], v19 offset:32832
  ds_read_b64_tr_b16 v[52:53], v19 offset:36864
  ds_read_b64_tr_b16 v[54:55], v19 offset:37440
  ds_read_b64_tr_b16 v[56:57], v19 offset:41472
  ds_read_b64_tr_b16 v[58:59], v19 offset:42048
  ds_read_b64_tr_b16 v[60:61], v19 offset:46080
  ds_read_b64_tr_b16 v[62:63], v19 offset:46656
  s_waitcnt lgkmcnt(0)
  s_mov_b32 s100, 262144
L_sp8:
  ds_read_b32 v16, v15 offset:16
  s_sub_u32 s100, s100, 1
  s_cbranch_scc1 L_spd8
  s_waitcnt lgkmcnt(0)
  v_readfirstlane_b32 s99, v16
  s_nop 0
  s_cmp_ge_u32 s99, 16
  s_cbranch_scc1 L_spd8
  s_sleep 2
  s_branch L_sp8
L_spd8:
  s_mov_b32 s100, 262144
L_sp9:
  ds_read_b32 v16, v15 offset:32
  ds_read_b128 v[64:67], v23 offset:10752
  ds_read_b128 v[68:71], v23 offset:10816
  ds_read_b128 v[72:75], v23 offset:10880
  ds_read_b128 v[76:79], v23 offset:10944
  s_sub_u32 s100, s100, 1
  s_cbranch_scc1 L_spd9
  s_waitcnt lgkmcnt(4)
  v_readfirstlane_b32 s99, v16
  s_nop 0
  s_cmp_ge_u32 s99, 4
  s_cbranch_scc0 L_sp9
L_spd9:
  ds_read_b128 v[80:83], v23 offset:11008
  ds_read_b128 v[84:87], v23 offset:11072
  ds_read_b128 v[88:91], v23 offset:11136
  ds_read_b128 v[92:95], v23 offset:11200
  s_waitcnt lgkmcnt(7)
  v_mfma_f32_16x16x32_bf16 v[24:27], v[64:67], v[32:35], 0
  s_waitcnt lgkmcnt(6)
  v_mfma_f32_16x16x32_bf16 v[24:27], v[68:71], v[36:39], v[24:27]
  s_waitcnt lgkmcnt(5)
  v_mfma_f32_16x16x32_bf16 v[24:27], v[72:75], v[40:43], v[24:27]
  s_waitcnt lgkmcnt(4)
  v_mfma_f32_16x16x32_bf16 v[24:27], v[76:79], v[44:47], v[24:27]
  s_waitcnt lgkmcnt(3)
  v_mfma_f32_16x16x32_bf16 v[24:27], v[80:83], v[48:51], v[24:27]
  s_waitcnt lgkmcnt(2)
  v_mfma_f32_16x16x32_bf16 v[24:27], v[84:87], v[52:55], v[24:27]
  s_waitcnt lgkmcnt(1)
  v_mfma_f32_16x16x32_bf16 v[24:27], v[88:91], v[56:59], v[24:27]
  s_waitcnt lgkmcnt(0)
  v_mfma_f32_16x16x32_bf16 v[24:27], v[92:95], v[60:63], v[24:27]
  s_mov_b64 exec, 0xffff
  s_nop 6
  v_bfi_b32 v24, v12, s94, v24
  buffer_store_dword v24, v18, s[60:63], s37 offen sc1
  s_endpgm
L_role_ffn:
  v_and_b32 v6, 3, v1
  v_lshrrev_b32 v17, 4, v1
  v_bfe_u32 v19, v1, 2, 2
  s_and_b32 s101, s3, 3
  s_cmp_lt_u32 s3, 8
  s_cbranch_scc1 L_f_lo
  v_and_b32 v22, 15, v1
  v_lshl_add_u32 v23, v22, 2, v17
  s_and_b32 s97, s3, 7
  s_lshl_b32 s99, s97, 6
  v_add_lshl_u32 v5, v23, s99, 1
  ds_read_u16 v4, v5 offset:12800
  v_lshlrev_b32 v18, 12, v17
  v_lshl_add_u32 v18, v19, 7, v18
  v_lshl_add_u32 v18, v6, 4, v18
  s_lshl_b32 s96, s97, 9
  s_add_u32 s96, s96, 1048576
  s_mov_b32 s59, 0x20000
  s_add_u32 s84, s96, 16384
  s_add_u32 s85, s96, 32768
  s_add_u32 s86, s96, 49152
  s_mov_b64 s[40:41], -1
  s_mov_b64 s[42:43], -1
  s_mov_b64 s[44:45], -1
  s_mov_b64 s[46:47], -1
  s_cmp_ge_u32 s3, 12
  s_cbranch_scc1 L_f_w2
  s_mov_b32 s56, s16
  s_and_b32 s57, s17, 0xffff
  s_mov_b32 s58, 1409024
  v_lshrrev_b32 v22, 2, v1
  v_and_b32 v21, 3, v1
  v_mul_u32_u24 v20, 2752, v22
  v_lshl_add_u32 v20, v21, 4, v20
  s_lshl_b32 s36, s98, 6
  s_mul_i32 s37, s101, 352256
  s_add_u32 s36, s36, s37
  s_add_u32 s36, s36, 0
  s_mov_b32 s37, 44032
  v_mul_u32_u24 v22, 80, v22
  v_lshl_add_u32 v22, v21, 4, v22
  s_mul_i32 s99, s101, 10240
  s_add_u32 s99, s99, 13824
  v_add_u32 v22, s99, v22
  s_mov_b32 s100, 262144
L_sp10:
  ds_read_b32 v16, v15 offset:20
  s_sub_u32 s100, s100, 1
  s_cbranch_scc1 L_spd10
  s_waitcnt lgkmcnt(0)
  v_readfirstlane_b32 s99, v16
  s_nop 0
  s_cmp_ge_u32 s99, 4
  s_cbranch_scc1 L_spd10
  s_sleep 1
  s_branch L_sp10
L_spd10:
  s_setprio 2
  buffer_load_dwordx4 v[32:35], v20, s[56:59], s36 offen nt
  s_add_u32 s36, s36, s37
  buffer_load_dwordx4 v[36:39], v20, s[56:59], s36 offen nt
  s_add_u32 s36, s36, s37
  buffer_load_dwordx4 v[40:43], v20, s[56:59], s36 offen nt
  s_add_u32 s36, s36, s37
  buffer_load_dwordx4 v[44:47], v20, s[56:59], s36 offen nt
  s_add_u32 s36, s36, s37
  buffer_load_dwordx4 v[48:51], v20, s[56:59], s36 offen nt
  s_add_u32 s36, s36, s37
  buffer_load_dwordx4 v[52:55], v20, s[56:59], s36 offen nt
  s_add_u32 s36, s36, s37
  buffer_load_dwordx4 v[56:59], v20, s[56:59], s36 offen nt
  s_add_u32 s36, s36, s37
  buffer_load_dwordx4 v[60:63], v20, s[56:59], s36 offen nt
  s_setprio 0
  s_waitcnt vmcnt(7)
  ds_write_b128 v22, v[32:35] offset:0
  s_waitcnt vmcnt(6)
  ds_write_b128 v22, v[36:39] offset:1280
  s_waitcnt vmcnt(5)
  ds_write_b128 v22, v[40:43] offset:2560
  s_waitcnt vmcnt(4)
  ds_write_b128 v22, v[44:47] offset:3840
  s_waitcnt vmcnt(3)
  ds_write_b128 v22, v[48:51] offset:5120
  s_waitcnt vmcnt(2)
  ds_write_b128 v22, v[52:55] offset:6400
  s_waitcnt vmcnt(1)
  ds_write_b128 v22, v[56:59] offset:7680
  s_waitcnt vmcnt(0)
  ds_write_b128 v22, v[60:63] offset:8960
  s_mov_b64 exec, 0x1
  ds_add_u32 v15, v14 offset:24
  s_mov_b64 exec, -1
  buffer_load_dwordx4 v[96:99], v18, s[60:63], s96 offen sc1
  buffer_load_dwordx4 v[100:103], v18, s[60:63], s84 offen sc1
  buffer_load_dwordx4 v[104:107], v18, s[60:63], s85 offen sc1
  buffer_load_dwordx4 v[108:111], v18, s[60:63], s86 offen sc1
  s_branch L_f_n2
L_f_w2:
  s_mov_b32 s56, s20
  s_and_b32 s57, s21, 0xffff
  s_mov_b32 s58, 1409024
  s_lshl_b32 s36, s98, 15
  s_lshl_b32 s37, s101, 13
  s_add_u32 s36, s36, s37
  s_add_u32 s37, s36, 4096
  s_mul_i32 s99, s101, 8320
  s_add_u32 s99, s99, 54784
  v_add_u32 v22, s99, v2
  s_mov_b32 s100, 262144
L_sp11:
  ds_read_b32 v16, v15 offset:20
  s_sub_u32 s100, s100, 1
  s_cbranch_scc1 L_spd11
  s_waitcnt lgkmcnt(0)
  v_readfirstlane_b32 s99, v16
  s_nop 0
  s_cmp_ge_u32 s99, 4
  s_cbranch_scc1 L_spd11
  s_sleep 1
  s_branch L_sp11
L_spd11:
  buffer_load_dwordx4 v[32:35], v2, s[56:59], s36 offen offset:0 nt
  buffer_load_dwordx4 v[36:39], v2, s[56:59], s36 offen offset:1024 nt
  buffer_load_dwordx4 v[40:43], v2, s[56:59], s36 offen offset:2048 nt
  buffer_load_dwordx4 v[44:47], v2, s[56:59], s36 offen offset:3072 nt
  buffer_load_dwordx4 v[48:51], v2, s[56:59], s37 offen offset:0 nt
  buffer_load_dwordx4 v[52:55], v2, s[56:59], s37 offen offset:1024 nt
  buffer_load_dwordx4 v[56:59], v2, s[56:59], s37 offen offset:2048 nt
  buffer_load_dwordx4 v[60:63], v2, s[56:59], s37 offen offset:3072 nt
  s_waitcnt vmcnt(4)
  buffer_load_dwordx4 v[96:99], v18, s[60:63], s96 offen sc1
  buffer_load_dwordx4 v[100:103], v18, s[60:63], s84 offen sc1
  buffer_load_dwordx4 v[104:107], v18, s[60:63], s85 offen sc1
  buffer_load_dwordx4 v[108:111], v18, s[60:63], s86 offen sc1
  s_waitcnt vmcnt(11)
  ds_write_b128 v22, v[32:35] offset:0
  s_waitcnt vmcnt(10)
  ds_write_b128 v22, v[36:39] offset:1040
  s_waitcnt vmcnt(9)
  ds_write_b128 v22, v[40:43] offset:2080
  s_waitcnt vmcnt(8)
  ds_write_b128 v22, v[44:47] offset:3120
  s_waitcnt vmcnt(7)
  ds_write_b128 v22, v[48:51] offset:4160
  s_waitcnt vmcnt(6)
  ds_write_b128 v22, v[52:55] offset:5200
  s_waitcnt vmcnt(5)
  ds_write_b128 v22, v[56:59] offset:6240
  s_waitcnt vmcnt(4)
  ds_write_b128 v22, v[60:63] offset:7280
  s_mov_b64 exec, 0x1
  ds_add_u32 v15, v14 offset:28
  s_mov_b64 exec, -1
L_f_n2:
  v_lshlrev_b32 v4, 16, v4
  s_mov_b32 s100, 65536
  s_branch L_pb_w
L_pb:
  s_mov_b64 exec, s[40:41]
  s_cbranch_execz L_pb_s0
  buffer_load_dwordx4 v[96:99], v18, s[60:63], s96 offen sc1
L_pb_s0:
  s_mov_b64 exec, s[42:43]
  s_cbranch_execz L_pb_s1
  buffer_load_dwordx4 v[100:103], v18, s[60:63], s84 offen sc1
L_pb_s1:
  s_mov_b64 exec, s[44:45]
  s_cbranch_execz L_pb_s2
  buffer_load_dwordx4 v[104:107], v18, s[60:63], s85 offen sc1
L_pb_s2:
  s_mov_b64 exec, s[46:47]
  s_cbranch_execz L_pb_s3
  buffer_load_dwordx4 v[108:111], v18, s[60:63], s86 offen sc1
L_pb_s3:
L_pb_w:
  s_waitcnt vmcnt(0)
  s_mov_b64 exec, s[40:41]
  s_cbranch_execz L_pb_c0
  v_xor_b32 v64, s94, v96
  v_xor_b32 v65, s94, v97
  v_xor_b32 v66, s94, v98
  v_xor_b32 v67, s94, v99
  v_or3_b32 v16, v64, v65, v66
  v_or_b32 v16, v16, v67
  v_cmp_ne_u32_sdwa s[40:41], v16, v13 src0_sel:BYTE_0 src1_sel:DWORD
L_pb_c0:
  s_mov_b64 exec, s[42:43]
  s_cbranch_execz L_pb_c1
  v_xor_b32 v68, s94, v100
  v_xor_b32 v69, s94, v101
  v_xor_b32 v70, s94, v102
  v_xor_b32 v71, s94, v103
  v_or3_b32 v16, v68, v69, v70
  v_or_b32 v16, v16, v71
  v_cmp_ne_u32_sdwa s[42:43], v16, v13 src0_sel:BYTE_0 src1_sel:DWORD
L_pb_c1:
  s_mov_b64 exec, s[44:45]
  s_cbranch_execz L_pb_c2
  v_xor_b32 v72, s94, v104
  v_xor_b32 v73, s94, v105
  v_xor_b32 v74, s94, v106
  v_xor_b32 v75, s94, v107
  v_or3_b32 v16, v72, v73, v74
  v_or_b32 v16, v16, v75
  v_cmp_ne_u32_sdwa s[44:45], v16, v13 src0_sel:BYTE_0 src1_sel:DWORD
L_pb_c2:
  s_mov_b64 exec, s[46:47]
  s_cbranch_execz L_pb_c3
  v_xor_b32 v76, s94, v108
  v_xor_b32 v77, s94, v109
  v_xor_b32 v78, s94, v110
  v_xor_b32 v79, s94, v111
  v_or3_b32 v16, v76, v77, v78
  v_or_b32 v16, v16, v79
  v_cmp_ne_u32_sdwa s[46:47], v16, v13 src0_sel:BYTE_0 src1_sel:DWORD
L_pb_c3:
  s_or_b64 s[90:91], s[40:41], s[42:43]
  s_or_b64 s[88:89], s[44:45], s[46:47]
  s_or_b64 s[90:91], s[90:91], s[88:89]
  s_cbranch_scc0 L_pb_ok
  s_sub_u32 s100, s100, 1
  s_cbranch_scc0 L_pb
L_pb_ok:
  s_mov_b64 exec, -1
  v_add_f32 v24, v64, v68
  v_add_f32 v25, v65, v69
  v_add_f32 v26, v66, v70
  v_add_f32 v27, v67, v71
  v_add_f32 v28, v72, v76
  v_add_f32 v29, v73, v77
  v_add_f32 v30, v74, v78
  v_add_f32 v31, v75, v79
  v_add_f32 v24, v24, v28
  v_add_f32 v26, v26, v30
  v_add_f32 v25, v25, v29
  v_add_f32 v27, v27, v31
  v_permlane32_swap_b32 v24, v26
  s_nop 0
  v_permlane32_swap_b32 v25, v27
  v_add_f32 v24, v24, v26
  v_add_f32 v25, v25, v27
  s_nop 1
  v_permlane16_swap_b32 v24, v25
  v_add_f32 v24, v24, v25
  v_add_f32 v24, v24, v4
  v_cvt_pk_bf16_f32 v24, v24, v24
  ds_write_b16 v5, v24 offset:12800
  s_mov_b64 exec, 0x1
  ds_add_u32 v15, v14 offset:32
  s_endpgm
L_f_lo:
  v_lshl_add_u32 v19, v17, 3, v19
  s_cmp_ge_u32 s3, 4
  s_cbranch_scc1 L_f_g2
  s_and_b32 s97, s3, 1
  s_lshr_b32 s96, s3, 1
  v_and_b32 v22, 15, v1
  s_lshl_b32 s99, s97, 4
  v_add_lshl_u32 v23, v22, s99, 1
  s_lshl_b32 s99, s98, 6
  v_add_u32 v22, s99, v23
  s_mov_b64 exec, 0xffff
  global_load_ushort v7, v22, s[18:19]
  s_mov_b64 exec, -1
  v_mul_u32_u24 v19, 80, v19
  v_lshl_add_u32 v19, v6, 3, v19
  s_lshl_b32 s99, s97, 5
  s_mul_i32 s36, s96, 5120
  s_add_u32 s99, s99, s36
  v_add_u32 v19, s99, v19
  s_mov_b32 s37, 0x3f803f80
  v_mov_b32 v24, s37
  v_mov_b32 v25, s37
  v_mov_b32 v26, s37
  v_mov_b32 v27, s37
  v_lshlrev_b32 v18, 1, v23
  s_mov_b32 s100, 262144
L_sp12:
  ds_read_b32 v16, v15 offset:24
  s_sub_u32 s100, s100, 1
  s_cbranch_scc1 L_spd12
  s_waitcnt lgkmcnt(0)
  v_readfirstlane_b32 s99, v16
  s_nop 0
  s_cmp_ge_u32 s99, 4
  s_cbranch_scc1 L_spd12
  s_sleep 1
  s_branch L_sp12
L_spd12:
  ds_read_b64_tr_b16 v[32:33], v19 offset:13824
  ds_read_b64_tr_b16 v[34:35], v19 offset:14144
  ds_read_b64_tr_b16 v[36:37], v19 offset:16384
  ds_read_b64_tr_b16 v[38:39], v19 offset:16704
  ds_read_b64_tr_b16 v[40:41], v19 offset:24064
  ds_read_b64_tr_b16 v[42:43], v19 offset:24384
  ds_read_b64_tr_b16 v[44:45], v19 offset:26624
  ds_read_b64_tr_b16 v[46:47], v19 offset:26944
  s_waitcnt lgkmcnt(0)
  v_mfma_f32_16x16x32_bf16 v[8:11], v[24:27], v[32:35], 0
  v_mfma_f32_16x16x32_bf16 v[8:11], v[24:27], v[36:39], v[8:11]
  v_mfma_f32_16x16x32_bf16 v[8:11], v[24:27], v[40:43], v[8:11]
  v_mfma_f32_16x16x32_bf16 v[8:11], v[24:27], v[44:47], v[8:11]
  ds_read_b64_tr_b16 v[48:49], v19 offset:34304
  ds_read_b64_tr_b16 v[50:51], v19 offset:34624
  ds_read_b64_tr_b16 v[52:53], v19 offset:36864
  ds_read_b64_tr_b16 v[54:55], v19 offset:37184
  ds_read_b64_tr_b16 v[56:57], v19 offset:44544
  ds_read_b64_tr_b16 v[58:59], v19 offset:44864
  ds_read_b64_tr_b16 v[60:61], v19 offset:47104
  ds_read_b64_tr_b16 v[62:63], v19 offset:47424
  s_waitcnt lgkmcnt(0)
  v_mfma_f32_16x16x32_bf16 v[8:11], v[24:27], v[48:51], v[8:11]
  v_mfma_f32_16x16x32_bf16 v[8:11], v[24:27], v[52:55], v[8:11]
  v_mfma_f32_16x16x32_bf16 v[8:11], v[24:27], v[56:59], v[8:11]
  v_mfma_f32_16x16x32_bf16 v[8:11], v[24:27], v[60:63], v[8:11]
  s_waitcnt vmcnt(0)
  v_lshlrev_b32 v7, 16, v7
  v_lshlrev_b32 v19, 4, v17
  s_lshl_b32 s99, s96, 7
  v_add_u32 v19, s99, v19
  v_mov_b32 v20, 0xc0135761
  v_mov_b32 v21, 0xbdd2d3e8
  s_setprio 3
  s_cmp_eq_u32 s96, 0
  s_cbranch_scc1 L_f_k0
  s_mov_b64 exec, 0xffff
  ds_write_b32 v18, v8 offset:10880
  s_mov_b64 exec, 0x1
  ds_add_u32 v15, v14 offset:40
  s_mov_b64 exec, -1
  s_mov_b32 s100, 262144
L_sp13:
  ds_read_b32 v16, v15 offset:32
  s_sub_u32 s100, s100, 1
  s_cbranch_scc1 L_spd13
  s_waitcnt lgkmcnt(0)
  v_readfirstlane_b32 s99, v16
  s_nop 0
  s_cmp_ge_u32 s99, 1
  s_cbranch_scc1 L_spd13
  s_sleep 1
  s_branch L_sp13
L_spd13:
  s_mov_b32 s100, 262144
L_sp14:
  ds_read_b32 v16, v15 offset:32
  ds_read_b128 v[64:67], v19 offset:12800
  ds_read_b128 v[68:71], v19 offset:12864
  ds_read_b128 v[72:75], v19 offset:13056
  ds_read_b128 v[76:79], v19 offset:13120
  s_sub_u32 s100, s100, 1
  s_cbranch_scc1 L_spd14
  s_waitcnt lgkmcnt(4)
  v_readfirstlane_b32 s99, v16
  s_nop 0
  s_cmp_ge_u32 s99, 8
  s_cbranch_scc0 L_sp14
L_spd14:
  ds_read_b128 v[80:83], v19 offset:13312
  ds_read_b128 v[84:87], v19 offset:13376
  ds_read_b128 v[88:91], v19 offset:13568
  ds_read_b128 v[92:95], v19 offset:13632
  s_waitcnt lgkmcnt(7)
  v_mfma_f32_16x16x32_bf16 v[24:27], v[64:67], v[32:35], 0
  s_waitcnt lgkmcnt(6)
  v_mfma_f32_16x16x32_bf16 v[24:27], v[68:71], v[36:39], v[24:27]
  s_waitcnt lgkmcnt(5)
  v_mfma_f32_16x16x32_bf16 v[24:27], v[72:75], v[40:43], v[24:27]
  s_waitcnt lgkmcnt(4)
  v_mfma_f32_16x16x32_bf16 v[24:27], v[76:79], v[44:47], v[24:27]
  s_waitcnt lgkmcnt(3)
  v_mfma_f32_16x16x32_bf16 v[24:27], v[80:83], v[48:51], v[24:27]
  s_waitcnt lgkmcnt(2)
  v_mfma_f32_16x16x32_bf16 v[24:27], v[84:87], v[52:55], v[24:27]
  s_waitcnt lgkmcnt(1)
  v_mfma_f32_16x16x32_bf16 v[24:27], v[88:91], v[56:59], v[24:27]
  s_waitcnt lgkmcnt(0)
  v_mfma_f32_16x16x32_bf16 v[24:27], v[92:95], v[60:63], v[24:27]
  s_mov_b64 exec, 0xffff
  s_nop 6
  ds_write_b32 v18, v24 offset:10752
  s_mov_b64 exec, 0x1
  ds_add_u32 v15, v14 offset:40
  s_endpgm
L_f_k0:
  s_mov_b32 s100, 262144
L_sp15:
  ds_read_b32 v16, v15 offset:40
  ds_read_b32 v22, v18 offset:10880
  s_sub_u32 s100, s100, 1
  s_cbranch_scc1 L_spd15
  s_waitcnt lgkmcnt(1)
  v_readfirstlane_b32 s99, v16
  s_nop 0
  s_cmp_ge_u32 s99, 2
  s_cbranch_scc0 L_sp15
L_spd15:
  s_waitcnt lgkmcnt(0)
  v_add_f32 v22, v22, v8
  s_mov_b32 s44, 0x3b003b00
  v_mov_b32 v11, 0x38a7c5ac
  v_mov_b32 v6, 0x3b000000
  s_mov_b32 s100, 262144
L_sp16:
  ds_read_b32 v16, v15 offset:32
  s_sub_u32 s100, s100, 1
  s_cbranch_scc1 L_spd16
  s_waitcnt lgkmcnt(0)
  v_readfirstlane_b32 s99, v16
  s_nop 0
  s_cmp_ge_u32 s99, 1
  s_cbranch_scc1 L_spd16
  s_sleep 1
  s_branch L_sp16
L_spd16:
  s_mov_b32 s100, 262144
L_sp17:
  ds_read_b32 v16, v15 offset:32
  ds_read_b128 v[28:31], v2 offset:12800
  ds_read_b128 v[64:67], v19 offset:12800
  s_sub_u32 s100, s100, 1
  s_cbranch_scc1 L_spd17
  s_waitcnt lgkmcnt(2)
  v_readfirstlane_b32 s99, v16
  s_nop 0
  s_cmp_ge_u32 s99, 8
  s_cbranch_scc0 L_sp17
L_spd17:
  ds_read_b128 v[68:71], v19 offset:12864
  ds_read_b128 v[72:75], v19 offset:13056
  ds_read_b128 v[76:79], v19 offset:13120
  ds_read_b128 v[80:83], v19 offset:13312
  ds_read_b128 v[84:87], v19 offset:13376
  ds_read_b128 v[88:91], v19 offset:13568
  ds_read_b128 v[92:95], v19 offset:13632
  s_waitcnt lgkmcnt(8)
  v_dot2_f32_bf16 v8, s44, v28, 0
  v_dot2_f32_bf16 v9, v28, v28, v11
  v_dot2_f32_bf16 v8, s44, v29, v8
  v_dot2_f32_bf16 v9, v29, v29, v9
  v_dot2_f32_bf16 v8, s44, v30, v8
  v_dot2_f32_bf16 v9, v30, v30, v9
  v_dot2_f32_bf16 v8, s44, v31, v8
  v_dot2_f32_bf16 v9, v31, v31, v9
  s_waitcnt lgkmcnt(7)
  v_mfma_f32_16x16x32_bf16 v[24:27], v[64:67], v[32:35], 0
  s_nop 0
  v_permlane32_swap_b32 v8, v9
  s_waitcnt lgkmcnt(6)
  v_mfma_f32_16x16x32_bf16 v[24:27], v[68:71], v[36:39], v[24:27]
  v_add_f32 v8, v8, v9
  s_waitcnt lgkmcnt(5)
  v_mfma_f32_16x16x32_bf16 v[24:27], v[72:75], v[40:43], v[24:27]
  v_add_f32_dpp v8, v8, v8 quad_perm:[1,0,3,2] row_mask:0xf bank_mask:0xf
  s_waitcnt lgkmcnt(4)
  v_mfma_f32_16x16x32_bf16 v[24:27], v[76:79], v[44:47], v[24:27]
  v_add_f32_dpp v8, v8, v8 quad_perm:[2,3,0,1] row_mask:0xf bank_mask:0xf
  s_waitcnt lgkmcnt(3)
  v_mfma_f32_16x16x32_bf16 v[24:27], v[80:83], v[48:51], v[24:27]
  v_add_f32_dpp v8, v8, v8 row_half_mirror row_mask:0xf bank_mask:0xf
  s_waitcnt lgkmcnt(2)
  v_mfma_f32_16x16x32_bf16 v[24:27], v[84:87], v[52:55], v[24:27]
  v_add_f32_dpp v8, v8, v8 row_mirror row_mask:0xf bank_mask:0xf
  s_waitcnt lgkmcnt(1)
  v_mfma_f32_16x16x32_bf16 v[24:27], v[88:91], v[56:59], v[24:27]
  v_add_f32_dpp v8, v8, v8 row_bcast:15 row_mask:0xa bank_mask:0xf
  s_waitcnt lgkmcnt(0)
  v_mfma_f32_16x16x32_bf16 v[24:27], v[92:95], v[60:63], v[24:27]
  v_readlane_b32 s36, v8, 31
  v_readlane_b32 s35, v8, 63
  ds_read_b32 v16, v15 offset:40
  ds_read_b32 v10, v18 offset:10752
  v_mov_b32 v8, s36
  v_mul_f32 v9, s35, v6
  v_fma_f32 v9, -v8, v8, v9
  v_cvt_pk_bf16_f32 v8, 0, v8
  v_max_f32 v9, 0x3727c5ac, v9
  v_rsq_f32 v9, v9
  v_fma_f32 v24, -v8, v22, v24
  s_waitcnt lgkmcnt(0)
  v_readfirstlane_b32 s99, v16
  s_nop 0
  s_cmp_ge_u32 s99, 4
  s_cbranch_scc1 L_f_k1
  s_mov_b32 s100, 262144
L_sp18:
  ds_read_b32 v16, v15 offset:40
  ds_read_b32 v10, v18 offset:10752
  s_sub_u32 s100, s100, 1
  s_cbranch_scc1 L_spd18
  s_waitcnt lgkmcnt(1)
  v_readfirstlane_b32 s99, v16
  s_nop 0
  s_cmp_ge_u32 s99, 4
  s_cbranch_scc0 L_sp18
L_spd18:
L_f_k1:
  s_waitcnt lgkmcnt(0)
  v_add_f32 v24, v24, v10
  v_fma_f32 v8, v24, v9, v7
  v_mul_f32 v9, v8, v8
  v_fma_f32 v9, v9, v21, v20
  v_mul_f32 v9, v8, v9
  v_exp_f32 v9, v9
  s_nop 0
  v_add_f32 v9, 1.0, v9
  v_rcp_f32 v9, v9
  s_nop 0
  v_mul_f32 v8, v8, v9
  s_mov_b64 exec, 0xffff
  v_cvt_pk_bf16_f32 v8, v8, v8
  ds_write_b16 v23, v8 offset:10688
  s_mov_b64 exec, 0x1
  ds_add_u32 v15, v14 offset:36
  s_endpgm
L_f_g2:
  v_mul_u32_u24 v19, 1040, v19
  v_lshl_add_u32 v19, v6, 3, v19
  s_lshl_b32 s99, s101, 8
  s_add_u32 s99, s99, 54784
  v_add_u32 v19, s99, v19
  s_lshl_b32 s35, s98, 11
  s_lshl_b32 s99, s101, 9
  s_add_u32 s35, s35, s99
  s_add_u32 s35, s35, 327680
  v_lshlrev_b32 v20, 4, v17
  v_add_u32 v20, 10688, v20
  v_mov_b32 v21, 10288
  v_and_b32 v22, 15, v1
  v_cmp_eq_u32 vcc, 0, v22
  s_nop 1
  v_cndmask_b32 v112, v21, v20, vcc
  v_cmp_eq_u32 vcc, 1, v22
  s_nop 1
  v_cndmask_b32 v113, v21, v20, vcc
  v_cmp_eq_u32 vcc, 2, v22
  s_nop 1
  v_cndmask_b32 v114, v21, v20, vcc
  v_cmp_eq_u32 vcc, 3, v22
  s_nop 1
  v_cndmask_b32 v115, v21, v20, vcc
  v_cmp_eq_u32 vcc, 4, v22
  s_nop 1
  v_cndmask_b32 v116, v21, v20, vcc
  v_cmp_eq_u32 vcc, 5, v22
  s_nop 1
  v_cndmask_b32 v117, v21, v20, vcc
  v_cmp_eq_u32 vcc, 6, v22
  s_nop 1
  v_cndmask_b32 v118, v21, v20, vcc
  v_cmp_eq_u32 vcc, 7, v22
  s_nop 1
  v_cndmask_b32 v119, v21, v20, vcc
  s_mov_b32 s100, 262144
L_sp19:
  ds_read_b32 v16, v15 offset:28
  s_sub_u32 s100, s100, 1
  s_cbranch_scc1 L_spd19
  s_waitcnt lgkmcnt(0)
  v_readfirstlane_b32 s99, v16
  s_nop 0
  s_cmp_ge_u32 s99, 4
  s_cbranch_scc1 L_spd19
  s_sleep 1
  s_branch L_sp19
L_spd19:
  ds_read_b64_tr_b16 v[32:33], v19 offset:0
  ds_read_b64_tr_b16 v[34:35], v19 offset:4160
  ds_read_b64_tr_b16 v[36:37], v19 offset:32
  ds_read_b64_tr_b16 v[38:39], v19 offset:4192
  ds_read_b64_tr_b16 v[40:41], v19 offset:64
  ds_read_b64_tr_b16 v[42:43], v19 offset:4224
  ds_read_b64_tr_b16 v[44:45], v19 offset:96
  ds_read_b64_tr_b16 v[46:47], v19 offset:4256
  ds_read_b64_tr_b16 v[48:49], v19 offset:128
  ds_read_b64_tr_b16 v[50:51], v19 offset:4288
  ds_read_b64_tr_b16 v[52:53], v19 offset:160
  ds_read_b64_tr_b16 v[54:55], v19 offset:4320
  ds_read_b64_tr_b16 v[56:57], v19 offset:192
  ds_read_b64_tr_b16 v[58:59], v19 offset:4352
  ds_read_b64_tr_b16 v[60:61], v19 offset:224
  ds_read_b64_tr_b16 v[62:63], v19 offset:4384
  s_waitcnt lgkmcnt(0)
  s_mov_b32 s100, 262144
L_sp20:
  ds_read_b32 v16, v15 offset:32
  s_sub_u32 s100, s100, 1
  s_cbranch_scc1 L_spd20
  s_waitcnt lgkmcnt(0)
  v_readfirstlane_b32 s99, v16
  s_nop 0
  s_cmp_ge_u32 s99, 8
  s_cbranch_scc1 L_spd20
  s_sleep 1
  s_branch L_sp20
L_spd20:
  s_mov_b32 s100, 262144
L_sp21:
  ds_read_b32 v16, v15 offset:36
  ds_read_b128 v[64:67], v112
  ds_read_b128 v[68:71], v113
  ds_read_b128 v[72:75], v114
  ds_read_b128 v[76:79], v115
  s_sub_u32 s100, s100, 1
  s_cbranch_scc1 L_spd21
  s_waitcnt lgkmcnt(4)
  v_readfirstlane_b32 s99, v16
  s_nop 0
  s_cmp_ge_u32 s99, 2
  s_cbranch_scc0 L_sp21
L_spd21:
  ds_read_b128 v[80:83], v116
  ds_read_b128 v[84:87], v117
  ds_read_b128 v[88:91], v118
  ds_read_b128 v[92:95], v119
  s_waitcnt lgkmcnt(7)
  v_mfma_f32_16x16x32_bf16 v[24:27], v[64:67], v[32:35], 0
  s_waitcnt lgkmcnt(6)
  v_mfma_f32_16x16x32_bf16 v[24:27], v[68:71], v[36:39], v[24:27]
  s_waitcnt lgkmcnt(5)
  v_mfma_f32_16x16x32_bf16 v[24:27], v[72:75], v[40:43], v[24:27]
  s_waitcnt lgkmcnt(4)
  v_mfma_f32_16x16x32_bf16 v[24:27], v[76:79], v[44:47], v[24:27]
  s_waitcnt lgkmcnt(3)
  v_mfma_f32_16x16x32_bf16 v[24:27], v[80:83], v[48:51], v[24:27]
  s_waitcnt lgkmcnt(2)
  v_mfma_f32_16x16x32_bf16 v[24:27], v[84:87], v[52:55], v[24:27]
  s_waitcnt lgkmcnt(1)
  v_mfma_f32_16x16x32_bf16 v[24:27], v[88:91], v[56:59], v[24:27]
  s_waitcnt lgkmcnt(0)
  v_mfma_f32_16x16x32_bf16 v[24:27], v[92:95], v[60:63], v[24:27]
  s_mov_b32 exec_hi, 0
  s_nop 6
  v_bfi_b32 v24, v12, s94, v24
  v_bfi_b32 v25, v12, s94, v25
  v_bfi_b32 v26, v12, s94, v26
  v_bfi_b32 v27, v12, s94, v27
  buffer_store_dwordx4 v[24:27], v2, s[60:63], s35 offen sc1
  s_endpgm
L_role_red:
  s_and_b32 s43, s31, 1
  v_and_b32 v22, 7, v1
  v_lshlrev_b32 v20, 2, v1
  s_cmp_eq_u32 s3, 6
  s_cbranch_scc1 L_red_f
  v_lshrrev_b32 v24, 3, v1
  v_lshlrev_b32 v19, 11, v24
  v_lshl_add_u32 v19, v22, 4, v19
  s_lshl1_add_u32 s97, s30, s43
  s_lshl_b32 s97, s97, 7
  s_lshl_b32 s99, s3, 14
  s_add_u32 s97, s97, s99
  s_add_u32 s97, s97, 327680
  s_lshl_b32 s99, s3, 8
  v_add_u32 v20, s99, v20
  v_mov_b32 v24, 0
  v_mov_b32 v25, 0
  v_mov_b32 v26, 0
  v_mov_b32 v27, 0
  s_mov_b32 s100, 262144
L_sp22:
  ds_read_b32 v16, v15 offset:32
  s_sub_u32 s100, s100, 1
  s_cbranch_scc1 L_spd22
  s_waitcnt lgkmcnt(0)
  v_readfirstlane_b32 s99, v16
  s_nop 0
  s_cmp_ge_u32 s99, 1
  s_cbranch_scc1 L_spd22
  s_sleep 2
  s_branch L_sp22
L_spd22:
  s_cmp_eq_u32 s3, 5
  s_cselect_b32 exec_lo, 0xffffff, -1
  s_cselect_b32 exec_hi, 0, -1
  buffer_load_dwordx4 v[32:35], v19, s[60:63], s97 offen sc1
  buffer_load_dwordx4 v[36:39], v19, s[60:63], s97 offen sc1
  buffer_load_dwordx4 v[40:43], v19, s[60:63], s97 offen sc1
  s_mov_b32 s100, 65536
L_pc:
  buffer_load_dwordx4 v[44:47], v19, s[60:63], s97 offen sc1
  s_waitcnt vmcnt(3)
  v_xor_b32 v24, s94, v32
  v_xor_b32 v25, s94, v33
  v_xor_b32 v26, s94, v34
  v_xor_b32 v27, s94, v35
  v_or3_b32 v16, v24, v25, v26
  v_or_b32 v16, v16, v27
  v_cmp_ne_u32_sdwa vcc, v16, v13 src0_sel:BYTE_0 src1_sel:DWORD
  s_cbranch_vccz L_pc_ok
  s_mov_b64 exec, vcc
  buffer_load_dwordx4 v[32:35], v19, s[60:63], s97 offen sc1
  s_waitcnt vmcnt(3)
  v_xor_b32 v24, s94, v36
  v_xor_b32 v25, s94, v37
  v_xor_b32 v26, s94, v38
  v_xor_b32 v27, s94, v39
  v_or3_b32 v16, v24, v25, v26
  v_or_b32 v16, v16, v27
  v_cmp_ne_u32_sdwa vcc, v16, v13 src0_sel:BYTE_0 src1_sel:DWORD
  s_cbranch_vccz L_pc_ok
  s_mov_b64 exec, vcc
  buffer_load_dwordx4 v[36:39], v19, s[60:63], s97 offen sc1
  s_waitcnt vmcnt(3)
  v_xor_b32 v24, s94, v40
  v_xor_b32 v25, s94, v41
  v_xor_b32 v26, s94, v42
  v_xor_b32 v27, s94, v43
  v_or3_b32 v16, v24, v25, v26
  v_or_b32 v16, v16, v27
  v_cmp_ne_u32_sdwa vcc, v16, v13 src0_sel:BYTE_0 src1_sel:DWORD
  s_cbranch_vccz L_pc_ok
  s_mov_b64 exec, vcc
  buffer_load_dwordx4 v[40:43], v19, s[60:63], s97 offen sc1
  s_waitcnt vmcnt(3)
  v_xor_b32 v24, s94, v44
  v_xor_b32 v25, s94, v45
  v_xor_b32 v26, s94, v46
  v_xor_b32 v27, s94, v47
  v_or3_b32 v16, v24, v25, v26
  v_or_b32 v16, v16, v27
  v_cmp_ne_u32_sdwa vcc, v16, v13 src0_sel:BYTE_0 src1_sel:DWORD
  s_cbranch_vccz L_pc_ok
  s_mov_b64 exec, vcc
  s_sub_u32 s100, s100, 1
  s_cbranch_scc0 L_pc
L_pc_ok:
  s_mov_b64 exec, -1
  v_add_f32_dpp v24, v24, v24 row_ror:8 row_mask:0xf bank_mask:0xf
  v_add_f32_dpp v25, v25, v25 row_ror:8 row_mask:0xf bank_mask:0xf
  v_add_f32_dpp v26, v26, v26 row_ror:8 row_mask:0xf bank_mask:0xf
  v_add_f32_dpp v27, v27, v27 row_ror:8 row_mask:0xf bank_mask:0xf
  v_permlane16_swap_b32 v24, v25
  s_nop 0
  v_permlane16_swap_b32 v26, v27
  v_add_f32 v24, v24, v25
  v_add_f32 v26, v26, v27
  s_nop 1
  v_permlane32_swap_b32 v24, v26
  v_add_f32 v24, v24, v26
  ds_write_b32 v20, v24 offset:10752
  s_mov_b64 exec, 0x1
  ds_add_u32 v15, v14 offset:36
  s_endpgm
L_red_f:
  v_lshrrev_b32 v17, 4, v1
  v_lshl_add_u32 v23, v17, 4, v22
  s_lshl_b32 s99, s30, 6
  s_lshl3_add_u32 s99, s43, s99
  v_add_lshl_u32 v5, v23, s99, 1
  ds_read_u16 v4, v5 offset:12800
  s_mov_b32 exec_lo, 0x00ff00ff
  s_mov_b32 exec_hi, 0x00ff00ff
  global_load_ushort v7, v5, s[22:23]
  s_mov_b64 exec, -1
  v_lshlrev_b32 v18, 12, v17
  v_bfe_u32 v24, v1, 1, 2
  v_lshl_add_u32 v18, v24, 7, v18
  v_and_b32 v25, 1, v1
  v_lshl_add_u32 v18, v25, 4, v18
  s_lshl_b32 s96, s30, 9
  s_lshl_b32 s99, s43, 5
  s_add_u32 s96, s96, s99
  s_add_u32 s96, s96, 1048576
  v_and_b32 v6, 3, v22
  v_lshlrev_b32 v6, 4, v6
  v_lshl_add_u32 v6, v17, 1, v6
  v_lshrrev_b32 v23, 2, v22
  v_add_lshl_u32 v6, v6, v23, 2
  s_add_u32 s84, s96, 16384
  s_add_u32 s85, s96, 32768
  s_add_u32 s86, s96, 49152
  s_mov_b64 s[40:41], -1
  s_mov_b64 s[42:43], -1
  s_mov_b64 s[44:45], -1
  s_mov_b64 s[46:47], -1
  s_mov_b32 s100, 262144
L_sp23:
  ds_read_b32 v16, v15 offset:20
  s_sub_u32 s100, s100, 1
  s_cbranch_scc1 L_spd23
  s_waitcnt lgkmcnt(0)
  v_readfirstlane_b32 s99, v16
  s_nop 0
  s_cmp_ge_u32 s99, 4
  s_cbranch_scc1 L_spd23
  s_sleep 2
  s_branch L_sp23
L_spd23:
  s_mov_b32 s100, 65536
L_pr:
  s_mov_b64 exec, s[40:41]
  s_cbranch_execz L_pr_s0
  buffer_load_dwordx4 v[96:99], v18, s[60:63], s96 offen sc1
L_pr_s0:
  s_mov_b64 exec, s[42:43]
  s_cbranch_execz L_pr_s1
  buffer_load_dwordx4 v[100:103], v18, s[60:63], s84 offen sc1
L_pr_s1:
  s_mov_b64 exec, s[44:45]
  s_cbranch_execz L_pr_s2
  buffer_load_dwordx4 v[104:107], v18, s[60:63], s85 offen sc1
L_pr_s2:
  s_mov_b64 exec, s[46:47]
  s_cbranch_execz L_pr_s3
  buffer_load_dwordx4 v[108:111], v18, s[60:63], s86 offen sc1
L_pr_s3:
L_pr_w:
  s_waitcnt vmcnt(0)
  s_mov_b64 exec, s[40:41]
  s_cbranch_execz L_pr_c0
  v_xor_b32 v64, s94, v96
  v_xor_b32 v65, s94, v97
  v_xor_b32 v66, s94, v98
  v_xor_b32 v67, s94, v99
  v_or3_b32 v16, v64, v65, v66
  v_or_b32 v16, v16, v67
  v_cmp_ne_u32_sdwa s[40:41], v16, v13 src0_sel:BYTE_0 src1_sel:DWORD
L_pr_c0:
  s_mov_b64 exec, s[42:43]
  s_cbranch_execz L_pr_c1
  v_xor_b32 v68, s94, v100
  v_xor_b32 v69, s94, v101
  v_xor_b32 v70, s94, v102
  v_xor_b32 v71, s94, v103
  v_or3_b32 v16, v68, v69, v70
  v_or_b32 v16, v16, v71
  v_cmp_ne_u32_sdwa s[42:43], v16, v13 src0_sel:BYTE_0 src1_sel:DWORD
L_pr_c1:
  s_mov_b64 exec, s[44:45]
  s_cbranch_execz L_pr_c2
  v_xor_b32 v72, s94, v104
  v_xor_b32 v73, s94, v105
  v_xor_b32 v74, s94, v106
  v_xor_b32 v75, s94, v107
  v_or3_b32 v16, v72, v73, v74
  v_or_b32 v16, v16, v75
  v_cmp_ne_u32_sdwa s[44:45], v16, v13 src0_sel:BYTE_0 src1_sel:DWORD
L_pr_c2:
  s_mov_b64 exec, s[46:47]
  s_cbranch_execz L_pr_c3
  v_xor_b32 v76, s94, v108
  v_xor_b32 v77, s94, v109
  v_xor_b32 v78, s94, v110
  v_xor_b32 v79, s94, v111
  v_or3_b32 v16, v76, v77, v78
  v_or_b32 v16, v16, v79
  v_cmp_ne_u32_sdwa s[46:47], v16, v13 src0_sel:BYTE_0 src1_sel:DWORD
L_pr_c3:
  s_or_b64 s[90:91], s[40:41], s[42:43]
  s_or_b64 s[88:89], s[44:45], s[46:47]
  s_or_b64 s[90:91], s[90:91], s[88:89]
  s_cbranch_scc0 L_pr_ok
  s_sub_u32 s100, s100, 1
  s_cbranch_scc0 L_pr
L_pr_ok:
  s_mov_b64 exec, -1
  v_add_f32 v24, v64, v68
  v_add_f32 v25, v65, v69
  v_add_f32 v26, v66, v70
  v_add_f32 v27, v67, v71
  v_add_f32 v28, v72, v76
  v_add_f32 v29, v73, v77
  v_add_f32 v30, v74, v78
  v_add_f32 v31, v75, v79
  v_add_f32 v24, v24, v28
  v_add_f32 v26, v26, v30
  v_add_f32 v25, v25, v29
  v_add_f32 v27, v27, v31
  v_permlane32_swap_b32 v24, v26
  s_nop 0
  v_permlane32_swap_b32 v25, v27
  v_add_f32 v24, v24, v26
  v_add_f32 v25, v25, v27
  s_nop 1
  v_permlane16_swap_b32 v24, v25
  v_add_f32 v24, v24, v25
  s_mov_b64 exec, 0x1
  ds_add_u32 v15, v14 offset:32
  s_mov_b64 exec, -1
  ds_bpermute_b32 v24, v6, v24
  v_lshlrev_b32 v4, 16, v4
  v_lshlrev_b32 v7, 16, v7
  s_waitcnt lgkmcnt(0)
  v_add_f32 v4, v24, v4
  v_cvt_pk_bf16_f32 v4, 0, v4
  v_add_f32 v4, v4, v7
  s_waitcnt vmcnt(0)
  s_mov_b32 s100, 262144
L_sp24:
  ds_read_b32 v16, v15 offset:36
  ds_read2st64_b32 v[24:25], v20 offset0:42 offset1:43
  ds_read2st64_b32 v[26:27], v20 offset0:44 offset1:45
  ds_read2st64_b32 v[28:29], v20 offset0:46 offset1:47
  s_sub_u32 s100, s100, 1
  s_cbranch_scc1 L_spd24
  s_waitcnt lgkmcnt(3)
  v_readfirstlane_b32 s99, v16
  s_nop 0
  s_cmp_ge_u32 s99, 6
  s_cbranch_scc0 L_sp24
L_spd24:
  s_waitcnt lgkmcnt(2)
  v_add_f32 v24, v24, v25
  s_waitcnt lgkmcnt(1)
  v_add_f32 v26, v26, v27
  v_add_f32 v24, v24, v4
  s_waitcnt lgkmcnt(0)
  v_add_f32 v28, v28, v29
  v_add_f32 v24, v24, v26
  v_add_f32 v24, v24, v28
  s_mov_b32 exec_lo, 0xff00ff
  s_mov_b32 exec_hi, 0xff00ff
  v_cvt_pk_bf16_f32 v24, v24, v24
  global_store_short v5, v24, s[24:25]
  s_cmp_lg_u32 s96, 1048576
  s_cbranch_scc1 L_noep
  s_mov_b64 exec, 1
  v_mov_b32 v25, s94
  s_mov_b32 s99, 458752
  buffer_store_dword v25, off, s[60:63], s99
  s_mov_b64 exec, -1
L_noep:
  s_endpgm
L_hi:
  s_cmp_ge_u32 s3, 12
  s_cbranch_scc1 L_q
  s_load_dword s94, s[28:29], 458752
  v_mov_b32 v15, 10240
  v_mov_b32 v14, 1
  v_lshrrev_b32 v17, 4, v1
  v_and_b32 v18, 15, v1
  s_lshl3_add_u32 s39, s34, s33
  s_lshl_b32 s39, s39, 10
  v_and_b32 v20, 1, v18
  v_lshlrev_b32 v20, 4, v20
  v_mov_b32 v21, 0xffff
  v_lshlrev_b32 v21, v20, v21
  v_lshrrev_b32 v20, 1, v18
  v_cmp_eq_u32 vcc, 0, v20
  s_nop 1
  v_cndmask_b32 v4, 0, v21, vcc
  v_cmp_eq_u32 vcc, 1, v20
  s_nop 1
  v_cndmask_b32 v5, 0, v21, vcc
  v_cmp_eq_u32 vcc, 2, v20
  s_nop 1
  v_cndmask_b32 v6, 0, v21, vcc
  v_cmp_eq_u32 vcc, 3, v20
  s_nop 1
  v_cndmask_b32 v7, 0, v21, vcc
  v_mov_b32 v12, 0xff
  v_mov_b32 v13, 0
  v_lshlrev_b32 v3, 3, v18
  v_lshl_add_u32 v3, v17, 8, v3
  s_waitcnt lgkmcnt(0)
  s_add_u32 s94, s94, 1
  s_and_b32 s94, s94, 0xff
  s_branch L_kv
L_q:
  s_setprio 3
  s_mov_b32 s60, s28
  s_and_b32 s61, s29, 0xffff
  s_mov_b32 s62, 2097152
  s_mov_b32 s63, 0x20000
  s_load_dword s94, s[28:29], 458752
  v_mov_b32 v15, 10240
  v_mov_b32 v14, 1
  v_lshrrev_b32 v17, 4, v1
  v_and_b32 v18, 15, v1
  s_lshl3_add_u32 s39, s34, s33
  s_lshl_b32 s39, s39, 10
  v_and_b32 v20, 1, v18
  v_lshlrev_b32 v20, 4, v20
  v_mov_b32 v21, 0xffff
  v_lshlrev_b32 v21, v20, v21
  v_lshrrev_b32 v20, 1, v18
  v_cmp_eq_u32 vcc, 0, v20
  s_nop 1
  v_cndmask_b32 v4, 0, v21, vcc
  v_cmp_eq_u32 vcc, 1, v20
  s_nop 1
  v_cndmask_b32 v5, 0, v21, vcc
  v_cmp_eq_u32 vcc, 2, v20
  s_nop 1
  v_cndmask_b32 v6, 0, v21, vcc
  v_cmp_eq_u32 vcc, 3, v20
  s_nop 1
  v_cndmask_b32 v7, 0, v21, vcc
  v_mov_b32 v12, 0xff
  v_mov_b32 v13, 0
  v_lshlrev_b32 v3, 3, v18
  v_lshl_add_u32 v3, v17, 8, v3
  s_waitcnt lgkmcnt(0)
  s_add_u32 s94, s94, 1
  s_and_b32 s94, s94, 0xff
  s_lshl_b32 s101, s38, 9
  s_lshl1_add_u32 s36, s39, s101
  s_add_u32 s36, s36, 1572864
  s_lshl_b32 s37, s34, 14
  s_add_u32 s37, s37, s101
  s_add_u32 s37, s37, 1572864
  s_getreg_b32 s97, hwreg(HW_REG_XCC_ID, 0, 4)
  s_lshl_b32 s97, s97, 8
  s_cmp_lt_u32 s31, 16
  s_cbranch_scc1 L_q1
  v_lshrrev_b32 v21, 3, v1
  v_and_b32 v22, 7, v1
  v_mul_u32_u24 v21, 2304, v21
  v_lshl_add_u32 v21, v22, 4, v21
  s_lshr_b32 s99, s38, 1
  s_mul_i32 s99, s99, 18432
  s_and_b32 s101, s38, 1
  s_mul_i32 s101, s101, 1152
  s_add_u32 s99, s99, s101
  v_add_u32 v21, s99, v21
  s_waitcnt vmcnt(7)
  ds_write_b128 v21, v[64:67] offset:13824
  s_waitcnt vmcnt(6)
  ds_write_b128 v21, v[68:71] offset:13968
  s_waitcnt vmcnt(5)
  ds_write_b128 v21, v[72:75] offset:14112
  s_waitcnt vmcnt(4)
  ds_write_b128 v21, v[76:79] offset:14256
  s_waitcnt vmcnt(3)
  ds_write_b128 v21, v[80:83] offset:14400
  s_waitcnt vmcnt(2)
  ds_write_b128 v21, v[84:87] offset:14544
  s_waitcnt vmcnt(1)
  ds_write_b128 v21, v[88:91] offset:14688
  s_waitcnt vmcnt(0)
  ds_write_b128 v21, v[92:95] offset:14832
  s_mov_b64 exec, 0x1
  ds_add_u32 v15, v14 offset:24
  s_mov_b64 exec, -1
  s_or_b32 s97, s97, s94
  v_mov_b32 v20, s97
  s_mov_b64 exec, 1
  buffer_store_dword v20, off, s[60:63], s36 offset:256 sc1
  s_mov_b64 exec, -1
  s_waitcnt lgkmcnt(0)
  s_nop 0
  s_branch L_q2
L_q1:
  s_waitcnt vmcnt(8)
  ds_write_b128 v2, v[8:11] offset:12800
  ds_read_u16 v28, v19 offset:12800
  v_lshlrev_b32 v20, 16, v8
  v_and_b32 v21, 0xffff0000, v8
  v_lshlrev_b32 v22, 16, v9
  v_and_b32 v23, 0xffff0000, v9
  v_lshlrev_b32 v24, 16, v10
  v_and_b32 v25, 0xffff0000, v10
  v_lshlrev_b32 v26, 16, v11
  v_and_b32 v27, 0xffff0000, v11
  v_add_f32 v29, v20, v21
  v_add_f32 v30, v22, v23
  v_add_f32 v31, v24, v25
  v_add_f32 v16, v26, v27
  v_add_f32 v29, v29, v30
  v_add_f32 v31, v31, v16
  s_waitcnt lgkmcnt(0)
  v_add_f32 v8, v29, v31
  s_nop 1
  v_add_f32_dpp v8, v8, v8 quad_perm:[1,0,3,2] row_mask:0xf bank_mask:0xf
  s_nop 1
  v_add_f32_dpp v8, v8, v8 quad_perm:[2,3,0,1] row_mask:0xf bank_mask:0xf
  s_nop 1
  v_add_f32_dpp v8, v8, v8 row_half_mirror row_mask:0xf bank_mask:0xf
  s_nop 1
  v_add_f32_dpp v8, v8, v8 row_mirror row_mask:0xf bank_mask:0xf
  s_nop 1
  v_add_f32_dpp v8, v8, v8 row_bcast:15 row_mask:0xa bank_mask:0xf
  s_nop 1
  v_add_f32_dpp v8, v8, v8 row_bcast:31 row_mask:0xc bank_mask:0xf
  s_nop 0
  v_readlane_b32 s99, v8, 63
  v_mov_b32 v8, 0x3b000000
  s_nop 0
  v_mul_f32 v8, s99, v8
  v_sub_f32 v20, v20, v8
  v_sub_f32 v21, v21, v8
  v_sub_f32 v22, v22, v8
  v_sub_f32 v23, v23, v8
  v_sub_f32 v24, v24, v8
  v_sub_f32 v25, v25, v8
  v_sub_f32 v26, v26, v8
  v_sub_f32 v27, v27, v8
  v_mul_f32 v9, v20, v20
  v_mul_f32 v10, v21, v21
  v_fmac_f32 v9, v22, v22
  v_fmac_f32 v10, v23, v23
  v_fmac_f32 v9, v24, v24
  v_fmac_f32 v10, v25, v25
  v_fmac_f32 v9, v26, v26
  v_fmac_f32 v10, v27, v27
  v_add_f32 v9, v9, v10
  s_nop 1
  v_add_f32_dpp v9, v9, v9 quad_perm:[1,0,3,2] row_mask:0xf bank_mask:0xf
  s_nop 1
  v_add_f32_dpp v9, v9, v9 quad_perm:[2,3,0,1] row_mask:0xf bank_mask:0xf
  s_nop 1
  v_add_f32_dpp v9, v9, v9 row_half_mirror row_mask:0xf bank_mask:0xf
  s_nop 1
  v_add_f32_dpp v9, v9, v9 row_mirror row_mask:0xf bank_mask:0xf
  s_nop 1
  v_add_f32_dpp v9, v9, v9 row_bcast:15 row_mask:0xa bank_mask:0xf
  s_nop 1
  v_add_f32_dpp v9, v9, v9 row_bcast:31 row_mask:0xc bank_mask:0xf
  s_nop 0
  v_readlane_b32 s99, v9, 63
  v_mov_b32 v9, 0x3b000000
  s_nop 0
  v_mul_f32 v9, s99, v9
  v_cvt_pk_bf16_f32 v9, 0, v9
  v_cvt_pk_bf16_f32 v8, 0, v8
  v_add_f32 v9, 0x3727c5ac, v9
  v_cvt_pk_bf16_f32 v9, 0, v9
  v_sqrt_f32 v9, v9
  s_nop 0
  v_cvt_pk_bf16_f32 v9, 0, v9
  v_rcp_f32 v9, v9
  v_lshlrev_b32 v28, 16, v28
  v_sub_f32 v28, v28, v8
  v_cvt_pk_bf16_f32 v28, 0, v28
  v_mul_f32 v28, v28, v9
  v_cvt_pk_bf16_f32 v28, v28, v28
  s_nop 1
  v_and_b32_dpp v96, v28, v4 row_newbcast:0 row_mask:0xf bank_mask:0xf
  v_and_b32_dpp v97, v28, v5 row_newbcast:0 row_mask:0xf bank_mask:0xf
  v_and_b32_dpp v98, v28, v6 row_newbcast:0 row_mask:0xf bank_mask:0xf
  v_and_b32_dpp v99, v28, v7 row_newbcast:0 row_mask:0xf bank_mask:0xf
  v_and_b32_dpp v100, v28, v4 row_newbcast:1 row_mask:0xf bank_mask:0xf
  v_and_b32_dpp v101, v28, v5 row_newbcast:1 row_mask:0xf bank_mask:0xf
  v_and_b32_dpp v102, v28, v6 row_newbcast:1 row_mask:0xf bank_mask:0xf
  v_and_b32_dpp v103, v28, v7 row_newbcast:1 row_mask:0xf bank_mask:0xf
  v_and_b32_dpp v104, v28, v4 row_newbcast:2 row_mask:0xf bank_mask:0xf
  v_and_b32_dpp v105, v28, v5 row_newbcast:2 row_mask:0xf bank_mask:0xf
  v_and_b32_dpp v106, v28, v6 row_newbcast:2 row_mask:0xf bank_mask:0xf
  v_and_b32_dpp v107, v28, v7 row_newbcast:2 row_mask:0xf bank_mask:0xf
  v_and_b32_dpp v108, v28, v4 row_newbcast:3 row_mask:0xf bank_mask:0xf
  v_and_b32_dpp v109, v28, v5 row_newbcast:3 row_mask:0xf bank_mask:0xf
  v_and_b32_dpp v110, v28, v6 row_newbcast:3 row_mask:0xf bank_mask:0xf
  v_and_b32_dpp v111, v28, v7 row_newbcast:3 row_mask:0xf bank_mask:0xf
  v_and_b32_dpp v112, v28, v4 row_newbcast:4 row_mask:0xf bank_mask:0xf
  v_and_b32_dpp v113, v28, v5 row_newbcast:4 row_mask:0xf bank_mask:0xf
  v_and_b32_dpp v114, v28, v6 row_newbcast:4 row_mask:0xf bank_mask:0xf
  v_and_b32_dpp v115, v28, v7 row_newbcast:4 row_mask:0xf bank_mask:0xf
  v_and_b32_dpp v116, v28, v4 row_newbcast:5 row_mask:0xf bank_mask:0xf
  v_and_b32_dpp v117, v28, v5 row_newbcast:5 row_mask:0xf bank_mask:0xf
  v_and_b32_dpp v118, v28, v6 row_newbcast:5 row_mask:0xf bank_mask:0xf
  v_and_b32_dpp v119, v28, v7 row_newbcast:5 row_mask:0xf bank_mask:0xf
  v_and_b32_dpp v120, v28, v4 row_newbcast:6 row_mask:0xf bank_mask:0xf
  v_and_b32_dpp v121, v28, v5 row_newbcast:6 row_mask:0xf bank_mask:0xf
  v_and_b32_dpp v122, v28, v6 row_newbcast:6 row_mask:0xf bank_mask:0xf
  v_and_b32_dpp v123, v28, v7 row_newbcast:6 row_mask:0xf bank_mask:0xf
  v_and_b32_dpp v124, v28, v4 row_newbcast:7 row_mask:0xf bank_mask:0xf
  v_and_b32_dpp v125, v28, v5 row_newbcast:7 row_mask:0xf bank_mask:0xf
  v_and_b32_dpp v126, v28, v6 row_newbcast:7 row_mask:0xf bank_mask:0xf
  v_and_b32_dpp v127, v28, v7 row_newbcast:7 row_mask:0xf bank_mask:0xf
  s_waitcnt vmcnt(7)
  v_mfma_f32_16x16x32_bf16 v[24:27], v[96:99], v[64:67], 0
  s_waitcnt vmcnt(6)
  v_mfma_f32_16x16x32_bf16 v[24:27], v[100:103], v[68:71], v[24:27]
  s_waitcnt vmcnt(5)
  v_mfma_f32_16x16x32_bf16 v[24:27], v[104:107], v[72:75], v[24:27]
  s_waitcnt vmcnt(4)
  v_mfma_f32_16x16x32_bf16 v[24:27], v[108:111], v[76:79], v[24:27]
  s_waitcnt vmcnt(3)
  v_mfma_f32_16x16x32_bf16 v[24:27], v[112:115], v[80:83], v[24:27]
  s_waitcnt vmcnt(2)
  v_mfma_f32_16x16x32_bf16 v[24:27], v[116:119], v[84:87], v[24:27]
  s_waitcnt vmcnt(1)
  v_mfma_f32_16x16x32_bf16 v[24:27], v[120:123], v[88:91], v[24:27]
  s_waitcnt vmcnt(0)
  v_mfma_f32_16x16x32_bf16 v[24:27], v[124:127], v[92:95], v[24:27]
  s_lshl_b32 s99, s38, 9
  s_add_u32 s99, s99, 8192
  v_add_u32 v19, s99, v3
  s_lshl_b32 s99, s38, 7
  v_lshlrev_b32 v20, 9, v17
  v_lshl_add_u32 v20, v18, 3, v20
  v_add_u32 v20, s99, v20
  s_mov_b32 exec_hi, 0
  ds_write2_b64 v19, v[24:25], v[26:27] offset0:0 offset1:16
  s_mov_b64 exec, 0x1
  ds_add_u32 v15, v14 offset:0
  s_mov_b64 exec, -1
  s_mov_b32 s100, 262144
L_sp25:
  ds_read_b32 v16, v15 offset:0
  ds_read_b64 v[24:25], v20 offset:8192
  s_sub_u32 s100, s100, 1
  s_cbranch_scc1 L_spd25
  s_waitcnt lgkmcnt(1)
  v_readfirstlane_b32 s99, v16
  s_nop 0
  s_cmp_ge_u32 s99, 4
  s_cbranch_scc0 L_sp25
L_spd25:
  s_waitcnt lgkmcnt(0)
  v_mov_b32 v26, v24
  v_mov_b32 v27, v25
  s_nop 0
  v_permlane16_swap_b32 v24, v26
  v_permlane16_swap_b32 v25, v27
  v_add_f32 v24, v24, v26
  v_add_f32 v25, v25, v27
  v_mov_b32 v26, v24
  v_mov_b32 v27, v25
  s_nop 0
  v_permlane32_swap_b32 v24, v26
  v_permlane32_swap_b32 v25, v27
  v_add_f32 v24, v24, v26
  v_add_f32 v25, v25, v27
  v_and_b32 v20, 0xffffff00, v24
  v_and_b32 v22, 0xffffff00, v25
  v_sub_f32 v21, v24, v20
  v_sub_f32 v23, v25, v22
  v_writelane_b32 v20, s97, 16
  v_bfi_b32 v20, v12, s94, v20
  v_bfi_b32 v21, v12, s94, v21
  v_bfi_b32 v22, v12, s94, v22
  v_bfi_b32 v23, v12, s94, v23
  s_mov_b64 exec, 0x1ffff
  buffer_store_dwordx4 v[20:23], v2, s[60:63], s36 offen sc1
  s_mov_b64 exec, -1
L_q2:
  v_lshlrev_b32 v19, 11, v17
  v_lshl_add_u32 v19, v18, 4, v19
  s_waitcnt vmcnt(0)
  s_mov_b32 s100, 262144
L_sp26:
  ds_read_b32 v16, v15 offset:8
  s_sub_u32 s100, s100, 1
  s_cbranch_scc1 L_spd26
  s_waitcnt lgkmcnt(0)
  v_readfirstlane_b32 s99, v16
  s_nop 0
  s_cmp_ge_u32 s99, 4
  s_cbranch_scc1 L_spd26
  s_sleep 2
  s_branch L_sp26
L_spd26:
  s_mov_b32 s100, 65536
L_pq:
  buffer_load_dwordx4 v[32:35], v19, s[60:63], s37 offen sc1
  s_waitcnt vmcnt(0)
  v_xor_b32 v20, s94, v32
  v_xor_b32 v21, s94, v33
  v_xor_b32 v22, s94, v34
  v_xor_b32 v23, s94, v35
  v_or3_b32 v16, v20, v21, v22
  v_or_b32 v16, v16, v23
  v_cmp_ne_u32_sdwa vcc, v16, v13 src0_sel:BYTE_0 src1_sel:DWORD
  s_cbranch_vccz L_pq_ok
  s_mov_b64 exec, vcc
  s_sub_u32 s100, s100, 1
  s_cbranch_scc0 L_pq
L_pq_ok:
  s_mov_b64 exec, -1
  v_add_f32 v20, v20, v21
  v_add_f32 v21, v22, v23
  v_mov_b32 v22, v20
  v_mov_b32 v23, v21
  s_nop 0
  v_permlane16_swap_b32 v20, v22
  v_permlane16_swap_b32 v21, v23
  v_add_f32 v20, v20, v22
  v_add_f32 v21, v21, v23
  v_mov_b32 v22, v20
  v_mov_b32 v23, v21
  s_nop 0
  v_permlane32_swap_b32 v20, v22
  v_permlane32_swap_b32 v21, v23
  v_add_f32 v20, v20, v22
  v_add_f32 v21, v21, v23
  v_cvt_pk_bf16_f32 v20, v20, v21
  s_lshl_b32 s99, s38, 2
  v_add_u32 v19, s99, v2
  s_mov_b64 exec, 0xffff
  ds_write_b32 v19, v20 offset:10304
  s_mov_b64 exec, 0x1
  ds_add_u32 v15, v14 offset:4
  s_mov_b64 exec, -1
  s_setprio 2
  s_branch L_kv
L_end:
  s_endpgm
.section .rodata,"a"
.p2align 6
.amdhsa_kernel sequential_preLN__sliding_block_cached__dense_activation_gelu__decode_kernel
  .amdhsa_next_free_vgpr 128
  .amdhsa_next_free_sgpr 102
  .amdhsa_accum_offset 128
  .amdhsa_group_segment_fixed_size 0
  .amdhsa_kernarg_size 104
  .amdhsa_user_sgpr_count 2
  .amdhsa_user_sgpr_kernarg_segment_ptr 1
  .amdhsa_system_sgpr_workgroup_id_x 1
  .amdhsa_float_denorm_mode_32 3
.end_amdhsa_kernel
```
